```python
import torch

def _softmax(x, axis=-1):
    return torch.softmax(x, dim=axis)
def _gelu(x):
    return torch.nn.functional.gelu(x, approximate="tanh")
def _silu(x):
    return torch.nn.functional.silu(x)
def _sigmoid(x):
    return torch.sigmoid(x)
def _layernorm(x, axis=-1, eps=1e-5):
    m = x.mean(dim=axis, keepdim=True)
    v = x.var(dim=axis, keepdim=True, unbiased=False)
    return (x - m) / torch.sqrt(v + eps)
def _scatter_add(tgt, idx, src, axis=0):
    return tgt.clone().index_add_(axis, idx, src)
def _segment_sum(src, seg, n):
    out = torch.zeros((n,) + src.shape[1:], dtype=src.dtype)
    return out.index_add_(0, seg, src)
def _pad(x, pw):
    flat = tuple(v for pair in reversed(pw) for v in pair)
    return torch.nn.functional.pad(x, flat)

kernel_name = 'concat_heads__linear_kernel_hedgehog__ssm_conv_s5__prompt'

def setup_inputs():

    _w = (lambda a: (lambda t: t.to(torch.bfloat16) if t.is_floating_point() else t)(torch.as_tensor(a)))
    def _A_setup():
        B, S, D, H = 1, 2048, 640, 32
        Dh = D // H
        return {
            "x": _w((lambda *s: torch.randn(*s, dtype=torch.bfloat16) * 0.4)(B, S, D)),
            "wqkv": _w((lambda *s: torch.randn(*s, dtype=torch.bfloat16) * 0.4)(D, 3 * D)),
            "w_phi": _w((lambda *s: torch.randn(*s, dtype=torch.bfloat16) * 0.4)(H, Dh, Dh) * (Dh ** -0.5)),
            "wo": _w((lambda *s: torch.randn(*s, dtype=torch.bfloat16) * 0.05)(D, D)),
        }
    _A_in = _A_setup()

    def _B_setup():
        B, S, D = 1, 2048, 640
        P = D
        Lambda_re = -0.5 * (lambda _x: torch.exp(torch.as_tensor(_x)))((lambda *s: torch.randn(*s, dtype=torch.bfloat16) * 0.8)(P))
        Lambda_im = (lambda *s: torch.randn(*s, dtype=torch.bfloat16) * 0.8)(P) * 1.0
        B_re = (lambda *s: torch.randn(*s, dtype=torch.bfloat16) * 0.8)(P, D) * (D ** -0.5)
        B_im = (lambda *s: torch.randn(*s, dtype=torch.bfloat16) * 0.8)(P, D) * (D ** -0.5)
        C_re = (lambda *s: torch.randn(*s, dtype=torch.bfloat16) * 0.8)(D, P) * (P ** -0.5)
        C_im = (lambda *s: torch.randn(*s, dtype=torch.bfloat16) * 0.8)(D, P) * (P ** -0.5)
        log_dt = (lambda *s: torch.randn(*s, dtype=torch.bfloat16) * 0.8)(P) * 0.3 - 2.0
        Dskip = (lambda *s: torch.randn(*s, dtype=torch.bfloat16) * 0.8)(D)
        return {
            "x": _w((lambda *s: torch.randn(*s, dtype=torch.bfloat16) * 0.05)(B, S, D)),
            "Lambda_re": _w(Lambda_re),
            "Lambda_im": _w(Lambda_im),
            "B_re": _w(B_re),
            "B_im": _w(B_im),
            "C_re": _w(C_re),
            "C_im": _w(C_im),
            "log_dt": _w(log_dt),
            "Dskip": _w(Dskip),
        }
    _B_in = _B_setup()

    return {
        "A_x": _A_in["x"],
        "A_wqkv": _A_in["wqkv"],
        "A_w_phi": _A_in["w_phi"],
        "A_wo": _A_in["wo"],
        "B_x": _B_in["x"],
        "B_Lambda_re": _B_in["Lambda_re"],
        "B_Lambda_im": _B_in["Lambda_im"],
        "B_B_re": _B_in["B_re"],
        "B_B_im": _B_in["B_im"],
        "B_C_re": _B_in["C_re"],
        "B_C_im": _B_in["C_im"],
        "B_log_dt": _B_in["log_dt"],
        "B_Dskip": _B_in["Dskip"],
    }

def reference(A_x, A_wqkv, A_w_phi, A_wo, B_x, B_Lambda_re, B_Lambda_im, B_B_re, B_B_im, B_C_re, B_C_im, B_log_dt, B_Dskip):
    def _A_ref(x, wqkv, w_phi, wo):
        B, S, D = x.shape
        H = 32; Dh = D // H
        qkv = (lambda x, *d: x.permute(*d))((x @ wqkv).reshape(B, S, 3, H, Dh), 2, 0, 3, 1, 4)
        q, k, v = qkv[0], qkv[1], qkv[2]
        pq = torch.einsum("bhsd,hdf->bhsf", q, w_phi)
        pk = torch.einsum("bhsd,hdf->bhsf", k, w_phi)
        phi_q = torch.concatenate([_softmax(pq, axis=-1), _softmax(-pq, axis=-1)], axis=-1)
        phi_k = torch.concatenate([_softmax(pk, axis=-1), _softmax(-pk, axis=-1)], axis=-1)
        kv = torch.einsum("bhsf,bhsd->bhfd", phi_k, v)
        z  = torch.einsum("bhsf->bhf", phi_k)
        num = torch.einsum("bhqf,bhfd->bhqd", phi_q, kv)
        den = torch.einsum("bhqf,bhf->bhq", phi_q, z)[..., None] + 1e-6
        o = num / den
        return (lambda x, *d: x.permute(*d))(o, 0, 2, 1, 3).reshape(B, S, D) @ wo

    def _B_ref(x, Lambda_re, Lambda_im, B_re, B_im, C_re, C_im, log_dt, Dskip):
        Bsz, L, H = x.shape
        Lam = Lambda_re + 1j * Lambda_im
        Bmat = B_re + 1j * B_im
        Cmat = C_re + 1j * C_im
        dt = torch.exp(log_dt)
        Lam_bar = torch.exp(dt * Lam)
        B_bar = ((Lam_bar - 1.0) / Lam)[:, None] * Bmat
        Bu = torch.einsum("bld,pd->blp", x + 0j, B_bar)
        h = torch.zeros_like(Bu[:, 0, :])
        hs = []
        for t in range(L):
            h = Lam_bar[None, :] * h + Bu[:, t, :]
            hs.append(h)
        hseq = torch.stack(hs, 1)
        y = 2.0 * torch.einsum("blp,dp->bld", hseq, Cmat).real + x * Dskip[None, None, :]
        return y

    a = _A_ref(A_x, A_wqkv, A_w_phi, A_wo)
    b = _B_ref(B_x, B_Lambda_re, B_Lambda_im, B_B_re, B_B_im, B_C_re, B_C_im, B_log_dt, B_Dskip)
    return torch.concatenate([a, b], axis=-1)
```

```asm
; @launch grid=(256,1,1) block=(512,1,1) lds=163840
.amdgcn_target "amdgcn-amd-amdhsa--gfx950"
.text
.globl concat_heads__linear_kernel_hedgehog__ssm_conv_s5__prompt_kernel
.p2align 8
.type concat_heads__linear_kernel_hedgehog__ssm_conv_s5__prompt_kernel,@function
concat_heads__linear_kernel_hedgehog__ssm_conv_s5__prompt_kernel:
    s_cmp_ge_u32 s2, 256
    s_cbranch_scc1 L_end
    s_load_dwordx16 s[4:19], s[0:1], 0
    s_load_dwordx16 s[20:35], s[0:1], 64
    v_lshrrev_b32 v2, 6, v0
    v_and_b32 v1, 63, v0
    v_readfirstlane_b32 s58, v2
    s_and_b32 s75, s2, 7
    s_lshl_b32 s75, s75, 1
    s_lshr_b32 s62, s2, 7
    s_add_u32 s75, s75, s62
    s_bfe_u32 s81, s2, 0x30004
    s_mov_b32 s76, 0x3fb8aa3b
    s_mov_b32 s77, 0x3fb8aa3b
    s_sub_u32 s61, s58, 4
    s_bfe_u32 s63, s2, 0x20004
    s_lshr_b32 s64, s2, 6
    s_bitcmp1_b32 s2, 3
    s_cbranch_scc1 L_B
    s_and_b32 s62, s2, 4
    s_add_u32 s56, s62, s63
    s_and_b32 s62, s2, 3
    s_lshl_b32 s62, s62, 2
    s_add_u32 s57, s62, s64
    s_xor_b32 s82, s57, 1
    s_and_b32 s83, s75, 1
    s_lshl_b32 s83, s83, 2
    s_add_u32 s83, s83, s81
    s_and_b32 s83, s83, 7
    s_mul_i32 s63, s63, 3
    s_add_u32 s59, s63, s64
    s_cmp_ge_u32 s59, 10
    s_cselect_b32 s62, 10, 0
    s_sub_u32 s59, s59, s62
    s_lshl_b32 s59, s59, 7
    s_cmp_lt_u32 s58, 4
    s_cbranch_scc1 L_Acomp
    v_lshrrev_b32 v2, 3, v1
    v_and_b32 v3, 7, v1
    v_lshrrev_b32 v34, 1, v2
    v_xor_b32 v32, v3, v34
    v_xor_b32 v33, 4, v32
    v_lshlrev_b32 v32, 4, v32
    v_lshlrev_b32 v33, 4, v33
    v_mul_u32_u24 v34, 1280, v2
    s_lshl_b32 s62, s56, 8
    s_lshl_b32 s63, s61, 6
    s_add_u32 s62, s62, s63
    s_mul_i32 s62, s62, 1280
    v_add3_u32 v4, v34, v32, s62
    v_add3_u32 v5, v34, v33, s62
    v_add_u32 v5, 9216, v5
    v_add3_u32 v6, v34, v32, s62
    v_add_u32 v6, 18432, v6
    v_add3_u32 v7, v34, v33, s62
    v_add_u32 v7, 27648, v7
    v_lshrrev_b32 v2, 4, v1
    v_lshlrev_b32 v3, 2, v2
    v_sub_u32 v3, v1, v3
    v_and_b32 v3, 15, v3
    v_min_u32 v3, 14, v3
    v_mul_u32_u24 v12, 52, v3
    v_lshrrev_b32 v12, 8, v12
    v_mul_u32_u24 v12, 1200, v12
    v_lshl_add_u32 v12, v3, 4, v12
    v_mul_u32_u24 v2, 3840, v2
    s_mul_i32 s62, s57, 80
    s_mul_i32 s63, s82, 80
    v_mov_b32 v13, s62
    v_mov_b32 v14, s63
    v_cmp_gt_u32 vcc, 5, v3
    s_nop 1
    v_cndmask_b32 v13, v13, v14, vcc
    s_mul_i32 s62, s61, 61440
    v_add3_u32 v12, v12, v2, v13
    v_add_u32 v8, s62, v12
    v_add_u32 v9, 14336, v8
    v_add_u32 v10, 28672, v8
    v_add_u32 v11, 43008, v8
    s_lshl_b32 s72, s61, 13
    s_lshl_b32 s73, s61, 12
    s_waitcnt lgkmcnt(0)
    s_mov_b32 s40, s4
    s_and_b32 s41, s5, 0xffff
    s_mov_b32 s42, 2621440
    s_mov_b32 s43, 0x00020000
    s_mov_b32 s44, s6
    s_and_b32 s45, s7, 0xffff
    s_mov_b32 s46, 2457600
    s_mov_b32 s47, 0x00020000
    s_add_u32 m0, s73, 49152
    s_mul_i32 s71, s59, 1920
    buffer_load_dwordx4 v8, s[44:47], s71 offen offset:0  lds
    buffer_load_dwordx4 v9, s[44:47], s71 offen offset:1024  lds
    buffer_load_dwordx4 v10, s[44:47], s71 offen offset:2048  lds
    buffer_load_dwordx4 v11, s[44:47], s71 offen offset:3072  lds
    s_add_u32 m0, s72, 16384
    s_add_u32 s70, s59, 40960
    buffer_load_dwordx4 v4, s[40:43], s59 offen offset:0  lds
    buffer_load_dwordx4 v5, s[40:43], s59 offen offset:1024  lds
    buffer_load_dwordx4 v6, s[40:43], s59 offen offset:2048  lds
    buffer_load_dwordx4 v7, s[40:43], s59 offen offset:3072  lds
    s_add_u32 m0, s72, 20480
    s_nop 0
    buffer_load_dwordx4 v4, s[40:43], s70 offen offset:0  lds
    buffer_load_dwordx4 v5, s[40:43], s70 offen offset:1024  lds
    buffer_load_dwordx4 v6, s[40:43], s70 offen offset:2048  lds
    buffer_load_dwordx4 v7, s[40:43], s70 offen offset:3072  lds
    s_add_u32 s59, s59, 128
    s_cmp_ge_u32 s59, 1280
    s_cselect_b32 s59, 0, s59
    s_mov_b32 s36, s34
    s_and_b32 s37, s35, 0xffff
    s_mov_b32 s38, 17825792
    s_mov_b32 s39, 0x00020000
    v_mov_b32 v2, 0
    buffer_load_dword v26, v2, s[36:39], 0 offen sc1
    s_mov_b32 s80, s57
    s_mov_b32 s57, s82
    v_subrev_u32 v22, 256, v0
    s_mul_i32 s64, s57, 28672
    s_add_u32 s64, s64, 5242880
    v_lshl_add_u32 v16, v22, 4, s64
    v_cmp_lt_u32 vcc, 209, v22
    v_mov_b32 v2, 1073741824
    s_nop 0
    v_cndmask_b32 v16, v16, v2, vcc
    v_mov_b32 v24, 0x10001
    v_mov_b32 v2, 0
    v_cndmask_b32 v24, v24, v2, vcc
    v_and_b32 v23, 7, v1
    v_mul_u32_u24 v23, 3584, v23
    v_bfe_u32 v2, v1, 4, 1
    v_lshl_add_u32 v23, v2, 4, v23
    s_lshr_b32 s65, s61, 1
    s_mul_i32 s65, s65, 1680
    s_add_u32 s64, s64, s65
    s_and_b32 s65, s61, 1
    s_lshl_b32 s65, s65, 7
    s_add_u32 s64, s64, s65
    s_add_u32 s64, s64, 1344
    v_add_u32 v23, s64, v23
    v_lshl_add_u32 v64, v22, 1, 0
    v_cmp_lt_u32 vcc, 209, v64
    v_mov_b32 v68, 0
    v_mov_b32 v69, 210
    v_cndmask_b32 v65, v68, v69, vcc
    v_sub_u32 v64, v64, v65
    v_mov_b32 v69, 3584
    v_cndmask_b32 v65, v68, v69, vcc
    v_mul_u32_u24 v66, 3121, v64
    v_lshrrev_b32 v66, 16, v66
    v_mul_u32_u24 v68, 21, v66
    v_sub_u32 v67, v64, v68
    v_lshl_add_u32 v65, v66, 3, v65
    v_add_u32 v68, 8, v65
    v_cmp_lt_u32 vcc, 4, v66
    s_nop 1
    v_cndmask_b32 v65, v65, v68, vcc
    v_subrev_u32 v68, 10, v67
    v_cmp_lt_u32 vcc, 9, v67
    s_nop 1
    v_cndmask_b32 v68, v67, v68, vcc
    v_mov_b32 v69, 0
    v_mov_b32 v64, 4
    v_cndmask_b32 v69, v69, v64, vcc
    v_lshrrev_b32 v64, 2, v68
    v_lshl_add_u32 v69, v64, 3, v69
    v_and_b32 v68, 3, v68
    v_add_u32 v69, v69, v68
    v_mul_u32_u24 v69, 112, v69
    v_add_u32 v18, v69, v65
    v_subrev_u32 v68, 448, v18
    v_cmp_eq_u32 vcc, 20, v67
    s_nop 1
    v_cndmask_b32 v19, v18, v68, vcc
    v_lshl_add_u32 v64, v22, 1, 1
    v_cmp_lt_u32 vcc, 209, v64
    v_mov_b32 v68, 0
    v_mov_b32 v69, 210
    v_cndmask_b32 v65, v68, v69, vcc
    v_sub_u32 v64, v64, v65
    v_mov_b32 v69, 3584
    v_cndmask_b32 v65, v68, v69, vcc
    v_mul_u32_u24 v66, 3121, v64
    v_lshrrev_b32 v66, 16, v66
    v_mul_u32_u24 v68, 21, v66
    v_sub_u32 v67, v64, v68
    v_lshl_add_u32 v65, v66, 3, v65
    v_add_u32 v68, 8, v65
    v_cmp_lt_u32 vcc, 4, v66
    s_nop 1
    v_cndmask_b32 v65, v65, v68, vcc
    v_subrev_u32 v68, 10, v67
    v_cmp_lt_u32 vcc, 9, v67
    s_nop 1
    v_cndmask_b32 v68, v67, v68, vcc
    v_mov_b32 v69, 0
    v_mov_b32 v64, 4
    v_cndmask_b32 v69, v69, v64, vcc
    v_lshrrev_b32 v64, 2, v68
    v_lshl_add_u32 v69, v64, 3, v69
    v_and_b32 v68, 3, v68
    v_add_u32 v69, v69, v68
    v_mul_u32_u24 v69, 112, v69
    v_add_u32 v20, v69, v65
    v_subrev_u32 v68, 448, v20
    v_cmp_eq_u32 vcc, 20, v67
    s_nop 1
    v_cndmask_b32 v21, v20, v68, vcc
    v_mov_b32 v2, 7232
    v_cmp_lt_u32 vcc, 209, v22
    s_nop 1
    v_cndmask_b32 v18, v18, v2, vcc
    v_cndmask_b32 v19, v19, v2, vcc
    v_cndmask_b32 v20, v20, v2, vcc
    v_cndmask_b32 v21, v21, v2, vcc
    s_mov_b32 s57, s80
    s_mov_b32 s52, s10
    s_and_b32 s53, s11, 0xffff
    s_mov_b32 s54, 819200
    s_mov_b32 s55, 0x00020000
    v_lshrrev_b32 v110, 4, v1
    v_bfe_u32 v111, v1, 2, 2
    v_xor_b32 v111, v111, v110
    v_min_u32 v111, 2, v111
    v_lshlrev_b32 v111, 6, v111
    v_and_b32 v2, 3, v1
    v_lshl_add_u32 v111, v2, 4, v111
    s_mul_i32 s62, s81, 192
    v_add_u32 v111, s62, v111
    s_lshr_b32 s62, s61, 1
    s_mul_i32 s62, s62, 10
    s_and_b32 s63, s61, 1
    s_lshl_b32 s64, s63, 2
    v_add_u32 v108, s64, v110
    v_add_u32 v109, 0, v108
    v_add_u32 v2, 10, v109
    v_cmp_lt_u32 vcc, 9, v109
    s_nop 1
    v_cndmask_b32 v109, v109, v2, vcc
    s_add_u32 s65, s62, 0
    v_add_u32 v109, s65, v109
    v_mul_u32_u24 v109, 1280, v109
    v_add_u32 v100, v109, v111
    v_add_u32 v109, 8, v108
    v_add_u32 v2, 10, v109
    v_cmp_lt_u32 vcc, 9, v109
    s_nop 1
    v_cndmask_b32 v109, v109, v2, vcc
    s_add_u32 s65, s62, 0
    v_add_u32 v109, s65, v109
    v_mul_u32_u24 v109, 1280, v109
    v_add_u32 v101, v109, v111
    v_add_u32 v109, 0, v108
    v_add_u32 v2, 10, v109
    v_cmp_lt_u32 vcc, 9, v109
    s_nop 1
    v_cndmask_b32 v109, v109, v2, vcc
    s_add_u32 s65, s62, 40
    v_add_u32 v109, s65, v109
    v_mul_u32_u24 v109, 1280, v109
    v_add_u32 v102, v109, v111
    v_add_u32 v109, 8, v108
    v_add_u32 v2, 10, v109
    v_cmp_lt_u32 vcc, 9, v109
    s_nop 1
    v_cndmask_b32 v109, v109, v2, vcc
    s_add_u32 s65, s62, 40
    v_add_u32 v109, s65, v109
    v_mul_u32_u24 v109, 1280, v109
    v_add_u32 v103, v109, v111
    s_mul_i32 s65, s63, 40
    s_add_u32 s65, s65, s62
    s_add_u32 s65, s65, 26
    v_add_u32 v109, s65, v110
    v_mul_u32_u24 v109, 1280, v109
    v_add_u32 v104, v109, v111
    s_mul_i32 s83, s83, 102400
    s_lshl_b32 s100, s61, 10
    v_mov_b32 v60, 0
    v_mov_b32 v61, 0
    v_mul_u32_u24 v2, 112, v1
    ds_write_b64 v2, v[60:61] offset:5672
    ds_write_b64 v2, v[60:61] offset:5720
    s_add_u32 m0, s73, 98304
    s_mul_i32 s71, s59, 1920
    buffer_load_dwordx4 v8, s[44:47], s71 offen offset:0  lds
    buffer_load_dwordx4 v9, s[44:47], s71 offen offset:1024  lds
    buffer_load_dwordx4 v10, s[44:47], s71 offen offset:2048  lds
    buffer_load_dwordx4 v11, s[44:47], s71 offen offset:3072  lds
    s_add_u32 m0, s72, 65536
    s_add_u32 s70, s59, 40960
    buffer_load_dwordx4 v4, s[40:43], s59 offen offset:0  lds
    buffer_load_dwordx4 v5, s[40:43], s59 offen offset:1024  lds
    buffer_load_dwordx4 v6, s[40:43], s59 offen offset:2048  lds
    buffer_load_dwordx4 v7, s[40:43], s59 offen offset:3072  lds
    s_add_u32 m0, s72, 69632
    s_nop 0
    buffer_load_dwordx4 v4, s[40:43], s70 offen offset:0  lds
    buffer_load_dwordx4 v5, s[40:43], s70 offen offset:1024  lds
    buffer_load_dwordx4 v6, s[40:43], s70 offen offset:2048  lds
    buffer_load_dwordx4 v7, s[40:43], s70 offen offset:3072  lds
    s_add_u32 s59, s59, 128
    s_cmp_ge_u32 s59, 1280
    s_cselect_b32 s59, 0, s59
    s_waitcnt vmcnt(13)
    s_waitcnt lgkmcnt(0)
    s_barrier
    s_add_u32 m0, s73, 147456
    s_mul_i32 s71, s59, 1920
    buffer_load_dwordx4 v8, s[44:47], s71 offen offset:0  lds
    buffer_load_dwordx4 v9, s[44:47], s71 offen offset:1024  lds
    buffer_load_dwordx4 v10, s[44:47], s71 offen offset:2048  lds
    buffer_load_dwordx4 v11, s[44:47], s71 offen offset:3072  lds
    s_add_u32 m0, s72, 114688
    s_add_u32 s70, s59, 40960
    buffer_load_dwordx4 v4, s[40:43], s59 offen offset:0  lds
    buffer_load_dwordx4 v5, s[40:43], s59 offen offset:1024  lds
    buffer_load_dwordx4 v6, s[40:43], s59 offen offset:2048  lds
    buffer_load_dwordx4 v7, s[40:43], s59 offen offset:3072  lds
    s_add_u32 m0, s72, 118784
    s_nop 0
    buffer_load_dwordx4 v4, s[40:43], s70 offen offset:0  lds
    buffer_load_dwordx4 v5, s[40:43], s70 offen offset:1024  lds
    buffer_load_dwordx4 v6, s[40:43], s70 offen offset:2048  lds
    buffer_load_dwordx4 v7, s[40:43], s70 offen offset:3072  lds
    s_add_u32 s59, s59, 128
    s_cmp_ge_u32 s59, 1280
    s_cselect_b32 s59, 0, s59
    s_waitcnt vmcnt(12)
    s_barrier
    s_add_u32 m0, s73, 49152
    s_mul_i32 s71, s59, 1920
    buffer_load_dwordx4 v8, s[44:47], s71 offen offset:0  lds
    buffer_load_dwordx4 v9, s[44:47], s71 offen offset:1024  lds
    buffer_load_dwordx4 v10, s[44:47], s71 offen offset:2048  lds
    buffer_load_dwordx4 v11, s[44:47], s71 offen offset:3072  lds
    s_add_u32 m0, s72, 16384
    s_add_u32 s70, s59, 40960
    buffer_load_dwordx4 v4, s[40:43], s59 offen offset:0  lds
    buffer_load_dwordx4 v5, s[40:43], s59 offen offset:1024  lds
    buffer_load_dwordx4 v6, s[40:43], s59 offen offset:2048  lds
    buffer_load_dwordx4 v7, s[40:43], s59 offen offset:3072  lds
    s_add_u32 m0, s72, 20480
    s_nop 0
    buffer_load_dwordx4 v4, s[40:43], s70 offen offset:0  lds
    buffer_load_dwordx4 v5, s[40:43], s70 offen offset:1024  lds
    buffer_load_dwordx4 v6, s[40:43], s70 offen offset:2048  lds
    buffer_load_dwordx4 v7, s[40:43], s70 offen offset:3072  lds
    s_add_u32 s59, s59, 128
    s_cmp_ge_u32 s59, 1280
    s_cselect_b32 s59, 0, s59
    v_readfirstlane_b32 s60, v26
    s_add_u32 s60, s60, 1
    s_mul_i32 s60, s60, 0x9e3779b1
    s_waitcnt vmcnt(12)
    s_barrier
    s_add_u32 m0, s73, 98304
    s_mul_i32 s71, s59, 1920
    buffer_load_dwordx4 v8, s[44:47], s71 offen offset:0  lds
    buffer_load_dwordx4 v9, s[44:47], s71 offen offset:1024  lds
    buffer_load_dwordx4 v10, s[44:47], s71 offen offset:2048  lds
    buffer_load_dwordx4 v11, s[44:47], s71 offen offset:3072  lds
    s_add_u32 m0, s72, 65536
    s_add_u32 s70, s59, 40960
    buffer_load_dwordx4 v4, s[40:43], s59 offen offset:0  lds
    buffer_load_dwordx4 v5, s[40:43], s59 offen offset:1024  lds
    buffer_load_dwordx4 v6, s[40:43], s59 offen offset:2048  lds
    buffer_load_dwordx4 v7, s[40:43], s59 offen offset:3072  lds
    s_add_u32 m0, s72, 69632
    s_nop 0
    buffer_load_dwordx4 v4, s[40:43], s70 offen offset:0  lds
    buffer_load_dwordx4 v5, s[40:43], s70 offen offset:1024  lds
    buffer_load_dwordx4 v6, s[40:43], s70 offen offset:2048  lds
    buffer_load_dwordx4 v7, s[40:43], s70 offen offset:3072  lds
    s_add_u32 s59, s59, 128
    s_cmp_ge_u32 s59, 1280
    s_cselect_b32 s59, 0, s59
    s_waitcnt vmcnt(12)
    s_barrier
    s_add_u32 m0, s73, 147456
    s_mul_i32 s71, s59, 1920
    buffer_load_dwordx4 v8, s[44:47], s71 offen offset:0  lds
    buffer_load_dwordx4 v9, s[44:47], s71 offen offset:1024  lds
    buffer_load_dwordx4 v10, s[44:47], s71 offen offset:2048  lds
    buffer_load_dwordx4 v11, s[44:47], s71 offen offset:3072  lds
    s_add_u32 m0, s72, 114688
    s_add_u32 s70, s59, 40960
    buffer_load_dwordx4 v4, s[40:43], s59 offen offset:0  lds
    buffer_load_dwordx4 v5, s[40:43], s59 offen offset:1024  lds
    buffer_load_dwordx4 v6, s[40:43], s59 offen offset:2048  lds
    buffer_load_dwordx4 v7, s[40:43], s59 offen offset:3072  lds
    s_add_u32 m0, s72, 118784
    s_nop 0
    buffer_load_dwordx4 v4, s[40:43], s70 offen offset:0  lds
    buffer_load_dwordx4 v5, s[40:43], s70 offen offset:1024  lds
    buffer_load_dwordx4 v6, s[40:43], s70 offen offset:2048  lds
    buffer_load_dwordx4 v7, s[40:43], s70 offen offset:3072  lds
    s_add_u32 s59, s59, 128
    s_cmp_ge_u32 s59, 1280
    s_cselect_b32 s59, 0, s59
    s_waitcnt vmcnt(12)
    s_barrier
    s_add_u32 m0, s73, 49152
    s_mul_i32 s71, s59, 1920
    buffer_load_dwordx4 v8, s[44:47], s71 offen offset:0  lds
    buffer_load_dwordx4 v9, s[44:47], s71 offen offset:1024  lds
    buffer_load_dwordx4 v10, s[44:47], s71 offen offset:2048  lds
    buffer_load_dwordx4 v11, s[44:47], s71 offen offset:3072  lds
    s_add_u32 m0, s72, 16384
    s_add_u32 s70, s59, 40960
    buffer_load_dwordx4 v4, s[40:43], s59 offen offset:0  lds
    buffer_load_dwordx4 v5, s[40:43], s59 offen offset:1024  lds
    buffer_load_dwordx4 v6, s[40:43], s59 offen offset:2048  lds
    buffer_load_dwordx4 v7, s[40:43], s59 offen offset:3072  lds
    s_add_u32 m0, s72, 20480
    s_nop 0
    buffer_load_dwordx4 v4, s[40:43], s70 offen offset:0  lds
    buffer_load_dwordx4 v5, s[40:43], s70 offen offset:1024  lds
    buffer_load_dwordx4 v6, s[40:43], s70 offen offset:2048  lds
    buffer_load_dwordx4 v7, s[40:43], s70 offen offset:3072  lds
    s_add_u32 s59, s59, 128
    s_cmp_ge_u32 s59, 1280
    s_cselect_b32 s59, 0, s59
    s_waitcnt vmcnt(12)
    s_barrier
    s_add_u32 m0, s73, 98304
    s_mul_i32 s71, s59, 1920
    buffer_load_dwordx4 v8, s[44:47], s71 offen offset:0  lds
    buffer_load_dwordx4 v9, s[44:47], s71 offen offset:1024  lds
    buffer_load_dwordx4 v10, s[44:47], s71 offen offset:2048  lds
    buffer_load_dwordx4 v11, s[44:47], s71 offen offset:3072  lds
    s_add_u32 m0, s72, 65536
    s_add_u32 s70, s59, 40960
    buffer_load_dwordx4 v4, s[40:43], s59 offen offset:0  lds
    buffer_load_dwordx4 v5, s[40:43], s59 offen offset:1024  lds
    buffer_load_dwordx4 v6, s[40:43], s59 offen offset:2048  lds
    buffer_load_dwordx4 v7, s[40:43], s59 offen offset:3072  lds
    s_add_u32 m0, s72, 69632
    s_nop 0
    buffer_load_dwordx4 v4, s[40:43], s70 offen offset:0  lds
    buffer_load_dwordx4 v5, s[40:43], s70 offen offset:1024  lds
    buffer_load_dwordx4 v6, s[40:43], s70 offen offset:2048  lds
    buffer_load_dwordx4 v7, s[40:43], s70 offen offset:3072  lds
    s_add_u32 s59, s59, 128
    s_cmp_ge_u32 s59, 1280
    s_cselect_b32 s59, 0, s59
    s_waitcnt vmcnt(12)
    s_barrier
    s_add_u32 m0, s73, 147456
    s_mul_i32 s71, s59, 1920
    buffer_load_dwordx4 v8, s[44:47], s71 offen offset:0  lds
    buffer_load_dwordx4 v9, s[44:47], s71 offen offset:1024  lds
    buffer_load_dwordx4 v10, s[44:47], s71 offen offset:2048  lds
    buffer_load_dwordx4 v11, s[44:47], s71 offen offset:3072  lds
    s_add_u32 m0, s72, 114688
    s_add_u32 s70, s59, 40960
    buffer_load_dwordx4 v4, s[40:43], s59 offen offset:0  lds
    buffer_load_dwordx4 v5, s[40:43], s59 offen offset:1024  lds
    buffer_load_dwordx4 v6, s[40:43], s59 offen offset:2048  lds
    buffer_load_dwordx4 v7, s[40:43], s59 offen offset:3072  lds
    s_add_u32 m0, s72, 118784
    s_nop 0
    buffer_load_dwordx4 v4, s[40:43], s70 offen offset:0  lds
    buffer_load_dwordx4 v5, s[40:43], s70 offen offset:1024  lds
    buffer_load_dwordx4 v6, s[40:43], s70 offen offset:2048  lds
    buffer_load_dwordx4 v7, s[40:43], s70 offen offset:3072  lds
    s_add_u32 s59, s59, 128
    s_cmp_ge_u32 s59, 1280
    s_cselect_b32 s59, 0, s59
    s_waitcnt vmcnt(12)
    s_barrier
    s_add_u32 m0, s73, 49152
    s_mul_i32 s71, s59, 1920
    buffer_load_dwordx4 v8, s[44:47], s71 offen offset:0  lds
    buffer_load_dwordx4 v9, s[44:47], s71 offen offset:1024  lds
    buffer_load_dwordx4 v10, s[44:47], s71 offen offset:2048  lds
    buffer_load_dwordx4 v11, s[44:47], s71 offen offset:3072  lds
    s_add_u32 m0, s72, 16384
    s_add_u32 s70, s59, 40960
    buffer_load_dwordx4 v4, s[40:43], s59 offen offset:0  lds
    buffer_load_dwordx4 v5, s[40:43], s59 offen offset:1024  lds
    buffer_load_dwordx4 v6, s[40:43], s59 offen offset:2048  lds
    buffer_load_dwordx4 v7, s[40:43], s59 offen offset:3072  lds
    s_add_u32 m0, s72, 20480
    s_nop 0
    buffer_load_dwordx4 v4, s[40:43], s70 offen offset:0  lds
    buffer_load_dwordx4 v5, s[40:43], s70 offen offset:1024  lds
    buffer_load_dwordx4 v6, s[40:43], s70 offen offset:2048  lds
    buffer_load_dwordx4 v7, s[40:43], s70 offen offset:3072  lds
    s_add_u32 s59, s59, 128
    s_cmp_ge_u32 s59, 1280
    s_cselect_b32 s59, 0, s59
    s_waitcnt vmcnt(12)
    s_barrier
    s_waitcnt vmcnt(0)
    s_barrier
    s_barrier
    s_add_u32 m0, s100, 16384
    s_nop 0
    buffer_load_dwordx4 v100, s[52:55], s83 offen lds
    s_add_u32 m0, s100, 20480
    s_nop 0
    buffer_load_dwordx4 v101, s[52:55], s83 offen lds
    s_add_u32 m0, s100, 24576
    s_nop 0
    buffer_load_dwordx4 v102, s[52:55], s83 offen lds
    s_add_u32 m0, s100, 28672
    s_nop 0
    buffer_load_dwordx4 v103, s[52:55], s83 offen lds
    s_add_u32 m0, s100, 32768
    s_nop 0
    buffer_load_dwordx4 v104, s[52:55], s83 offen lds
    s_add_u32 s83, s83, 102400
    s_cmp_ge_u32 s83, 819200
    s_cselect_b32 s83, 0, s83
    s_add_u32 m0, s100, 36864
    s_nop 0
    buffer_load_dwordx4 v100, s[52:55], s83 offen lds
    s_add_u32 m0, s100, 40960
    s_nop 0
    buffer_load_dwordx4 v101, s[52:55], s83 offen lds
    s_add_u32 m0, s100, 45056
    s_nop 0
    buffer_load_dwordx4 v102, s[52:55], s83 offen lds
    s_add_u32 m0, s100, 49152
    s_nop 0
    buffer_load_dwordx4 v103, s[52:55], s83 offen lds
    s_add_u32 m0, s100, 53248
    s_nop 0
    buffer_load_dwordx4 v104, s[52:55], s83 offen lds
    s_add_u32 s83, s83, 102400
    s_cmp_ge_u32 s83, 819200
    s_cselect_b32 s83, 0, s83
    s_add_u32 m0, s100, 57344
    s_nop 0
    buffer_load_dwordx4 v100, s[52:55], s83 offen lds
    s_add_u32 m0, s100, 61440
    s_nop 0
    buffer_load_dwordx4 v101, s[52:55], s83 offen lds
    s_add_u32 m0, s100, 65536
    s_nop 0
    buffer_load_dwordx4 v102, s[52:55], s83 offen lds
    s_add_u32 m0, s100, 69632
    s_nop 0
    buffer_load_dwordx4 v103, s[52:55], s83 offen lds
    s_add_u32 m0, s100, 73728
    s_nop 0
    buffer_load_dwordx4 v104, s[52:55], s83 offen lds
    s_add_u32 s83, s83, 102400
    s_cmp_ge_u32 s83, 819200
    s_cselect_b32 s83, 0, s83
    s_add_u32 m0, s100, 77824
    s_nop 0
    buffer_load_dwordx4 v100, s[52:55], s83 offen lds
    s_add_u32 m0, s100, 81920
    s_nop 0
    buffer_load_dwordx4 v101, s[52:55], s83 offen lds
    s_add_u32 m0, s100, 86016
    s_nop 0
    buffer_load_dwordx4 v102, s[52:55], s83 offen lds
    s_add_u32 m0, s100, 90112
    s_nop 0
    buffer_load_dwordx4 v103, s[52:55], s83 offen lds
    s_barrier
    s_barrier
    s_add_u32 m0, s100, 94208
    s_nop 0
    buffer_load_dwordx4 v104, s[52:55], s83 offen lds
    s_add_u32 s83, s83, 102400
    s_cmp_ge_u32 s83, 819200
    s_cselect_b32 s83, 0, s83
    s_add_u32 m0, s100, 98304
    s_nop 0
    buffer_load_dwordx4 v100, s[52:55], s83 offen lds
    s_add_u32 m0, s100, 102400
    s_nop 0
    buffer_load_dwordx4 v101, s[52:55], s83 offen lds
    s_add_u32 m0, s100, 106496
    s_nop 0
    buffer_load_dwordx4 v102, s[52:55], s83 offen lds
    s_add_u32 m0, s100, 110592
    s_nop 0
    buffer_load_dwordx4 v103, s[52:55], s83 offen lds
    s_add_u32 m0, s100, 114688
    s_nop 0
    buffer_load_dwordx4 v104, s[52:55], s83 offen lds
    s_add_u32 s83, s83, 102400
    s_cmp_ge_u32 s83, 819200
    s_cselect_b32 s83, 0, s83
    s_add_u32 m0, s100, 118784
    s_nop 0
    buffer_load_dwordx4 v100, s[52:55], s83 offen lds
    s_add_u32 m0, s100, 122880
    s_nop 0
    buffer_load_dwordx4 v101, s[52:55], s83 offen lds
    s_add_u32 m0, s100, 126976
    s_nop 0
    buffer_load_dwordx4 v102, s[52:55], s83 offen lds
    s_add_u32 m0, s100, 131072
    s_nop 0
    buffer_load_dwordx4 v103, s[52:55], s83 offen lds
    s_add_u32 m0, s100, 135168
    s_nop 0
    buffer_load_dwordx4 v104, s[52:55], s83 offen lds
    s_add_u32 s83, s83, 102400
    s_cmp_ge_u32 s83, 819200
    s_cselect_b32 s83, 0, s83
    s_add_u32 m0, s100, 139264
    s_nop 0
    buffer_load_dwordx4 v100, s[52:55], s83 offen lds
    s_add_u32 m0, s100, 143360
    s_nop 0
    buffer_load_dwordx4 v101, s[52:55], s83 offen lds
    s_add_u32 m0, s100, 147456
    s_nop 0
    buffer_load_dwordx4 v102, s[52:55], s83 offen lds
    s_add_u32 m0, s100, 151552
    s_nop 0
    buffer_load_dwordx4 v103, s[52:55], s83 offen lds
    s_add_u32 m0, s100, 155648
    s_nop 0
    buffer_load_dwordx4 v104, s[52:55], s83 offen lds
    s_add_u32 s83, s83, 102400
    s_cmp_ge_u32 s83, 819200
    s_cselect_b32 s83, 0, s83
    s_add_u32 m0, s100, 159744
    s_nop 0
    buffer_load_dwordx4 v100, s[52:55], s83 offen lds
    s_lshl_b32 s66, s60, 15
    s_and_b32 s67, s60, 1
    s_or_b32 s66, s66, s67
    s_lshl_b32 s67, s60, 13
    s_bfe_u32 s69, s60, 0x10002
    s_or_b32 s67, s67, s69
    s_mov_b32 s69, 0
    s_and_b32 s79, s56, 3
    s_mul_i32 s79, s79, 7168
LAl_probe:
    buffer_load_dwordx4 v[76:79], v23, s[36:39], 0 offen sc1
    s_add_u32 s69, s69, 1
    s_cmp_ge_u32 s69, 0x40000
    s_cbranch_scc1 LAl_sum
    v_mov_b32 v72, 0
    s_waitcnt vmcnt(0)
    v_xor_b32 v64, s66, v76
    v_xor_b32 v65, s67, v77
    v_xor_b32 v66, s66, v78
    v_xor_b32 v67, s67, v79
    v_or3_b32 v72, v72, v64, v65
    v_or3_b32 v72, v72, v66, v67
    v_and_b32 v72, 0x10001, v72
    v_cmp_ne_u32 vcc, 0, v72
    s_cmp_lg_u64 vcc, 0
    s_cbranch_scc1 LAl_probe
    s_mov_b32 s62, s79
    buffer_load_dwordx4 v[112:115], v16, s[36:39], s62 offen sc1
    s_add_u32 s62, s62, 3584
    buffer_load_dwordx4 v[116:119], v16, s[36:39], s62 offen sc1
    s_add_u32 s62, s62, 3584
    s_cmp_eq_u32 s62, 28672
    s_cselect_b32 s62, 0, s62
    buffer_load_dwordx4 v[120:123], v16, s[36:39], s62 offen sc1
    s_add_u32 s62, s62, 3584
    buffer_load_dwordx4 v[124:127], v16, s[36:39], s62 offen sc1
    s_add_u32 s62, s62, 3584
    s_cmp_eq_u32 s62, 28672
    s_cselect_b32 s62, 0, s62
    buffer_load_dwordx4 v[128:131], v16, s[36:39], s62 offen sc1
    s_add_u32 s62, s62, 3584
    buffer_load_dwordx4 v[132:135], v16, s[36:39], s62 offen sc1
    s_add_u32 s62, s62, 3584
    s_cmp_eq_u32 s62, 28672
    s_cselect_b32 s62, 0, s62
    buffer_load_dwordx4 v[136:139], v16, s[36:39], s62 offen sc1
    s_add_u32 s62, s62, 3584
    buffer_load_dwordx4 v[140:143], v16, s[36:39], s62 offen sc1
    s_waitcnt vmcnt(7)
    v_xor_b32 v64, s66, v112
    v_xor_b32 v65, s67, v113
    v_xor_b32 v66, s66, v114
    v_xor_b32 v67, s67, v115
    v_or3_b32 v72, v72, v64, v65
    v_or3_b32 v72, v72, v66, v67
    v_lshlrev_b32 v80, 16, v112
    v_and_b32 v81, 0xffff0000, v112
    v_lshlrev_b32 v82, 16, v113
    v_and_b32 v83, 0xffff0000, v113
    v_lshlrev_b32 v84, 16, v114
    v_and_b32 v85, 0xffff0000, v114
    v_lshlrev_b32 v86, 16, v115
    v_and_b32 v87, 0xffff0000, v115
    s_waitcnt vmcnt(6)
    v_xor_b32 v64, s66, v116
    v_xor_b32 v65, s67, v117
    v_xor_b32 v66, s66, v118
    v_xor_b32 v67, s67, v119
    v_or3_b32 v72, v72, v64, v65
    v_or3_b32 v72, v72, v66, v67
    v_lshlrev_b32 v88, 16, v116
    v_and_b32 v89, 0xffff0000, v116
    v_lshlrev_b32 v90, 16, v117
    v_and_b32 v91, 0xffff0000, v117
    v_lshlrev_b32 v92, 16, v118
    v_and_b32 v93, 0xffff0000, v118
    v_lshlrev_b32 v94, 16, v119
    v_and_b32 v95, 0xffff0000, v119
    v_pk_add_f32 v[80:81], v[80:81], v[88:89]
    v_pk_add_f32 v[82:83], v[82:83], v[90:91]
    v_pk_add_f32 v[84:85], v[84:85], v[92:93]
    v_pk_add_f32 v[86:87], v[86:87], v[94:95]
    s_waitcnt vmcnt(5)
    v_xor_b32 v64, s66, v120
    v_xor_b32 v65, s67, v121
    v_xor_b32 v66, s66, v122
    v_xor_b32 v67, s67, v123
    v_or3_b32 v72, v72, v64, v65
    v_or3_b32 v72, v72, v66, v67
    v_lshlrev_b32 v88, 16, v120
    v_and_b32 v89, 0xffff0000, v120
    v_lshlrev_b32 v90, 16, v121
    v_and_b32 v91, 0xffff0000, v121
    v_lshlrev_b32 v92, 16, v122
    v_and_b32 v93, 0xffff0000, v122
    v_lshlrev_b32 v94, 16, v123
    v_and_b32 v95, 0xffff0000, v123
    v_pk_add_f32 v[80:81], v[80:81], v[88:89]
    v_pk_add_f32 v[82:83], v[82:83], v[90:91]
    v_pk_add_f32 v[84:85], v[84:85], v[92:93]
    v_pk_add_f32 v[86:87], v[86:87], v[94:95]
    s_waitcnt vmcnt(4)
    v_xor_b32 v64, s66, v124
    v_xor_b32 v65, s67, v125
    v_xor_b32 v66, s66, v126
    v_xor_b32 v67, s67, v127
    v_or3_b32 v72, v72, v64, v65
    v_or3_b32 v72, v72, v66, v67
    v_lshlrev_b32 v88, 16, v124
    v_and_b32 v89, 0xffff0000, v124
    v_lshlrev_b32 v90, 16, v125
    v_and_b32 v91, 0xffff0000, v125
    v_lshlrev_b32 v92, 16, v126
    v_and_b32 v93, 0xffff0000, v126
    v_lshlrev_b32 v94, 16, v127
    v_and_b32 v95, 0xffff0000, v127
    v_pk_add_f32 v[80:81], v[80:81], v[88:89]
    v_pk_add_f32 v[82:83], v[82:83], v[90:91]
    v_pk_add_f32 v[84:85], v[84:85], v[92:93]
    v_pk_add_f32 v[86:87], v[86:87], v[94:95]
    s_waitcnt vmcnt(3)
    v_xor_b32 v64, s66, v128
    v_xor_b32 v65, s67, v129
    v_xor_b32 v66, s66, v130
    v_xor_b32 v67, s67, v131
    v_or3_b32 v72, v72, v64, v65
    v_or3_b32 v72, v72, v66, v67
    v_lshlrev_b32 v88, 16, v128
    v_and_b32 v89, 0xffff0000, v128
    v_lshlrev_b32 v90, 16, v129
    v_and_b32 v91, 0xffff0000, v129
    v_lshlrev_b32 v92, 16, v130
    v_and_b32 v93, 0xffff0000, v130
    v_lshlrev_b32 v94, 16, v131
    v_and_b32 v95, 0xffff0000, v131
    v_pk_add_f32 v[80:81], v[80:81], v[88:89]
    v_pk_add_f32 v[82:83], v[82:83], v[90:91]
    v_pk_add_f32 v[84:85], v[84:85], v[92:93]
    v_pk_add_f32 v[86:87], v[86:87], v[94:95]
    s_waitcnt vmcnt(2)
    v_xor_b32 v64, s66, v132
    v_xor_b32 v65, s67, v133
    v_xor_b32 v66, s66, v134
    v_xor_b32 v67, s67, v135
    v_or3_b32 v72, v72, v64, v65
    v_or3_b32 v72, v72, v66, v67
    v_lshlrev_b32 v88, 16, v132
    v_and_b32 v89, 0xffff0000, v132
    v_lshlrev_b32 v90, 16, v133
    v_and_b32 v91, 0xffff0000, v133
    v_lshlrev_b32 v92, 16, v134
    v_and_b32 v93, 0xffff0000, v134
    v_lshlrev_b32 v94, 16, v135
    v_and_b32 v95, 0xffff0000, v135
    v_pk_add_f32 v[80:81], v[80:81], v[88:89]
    v_pk_add_f32 v[82:83], v[82:83], v[90:91]
    v_pk_add_f32 v[84:85], v[84:85], v[92:93]
    v_pk_add_f32 v[86:87], v[86:87], v[94:95]
    s_waitcnt vmcnt(1)
    v_xor_b32 v64, s66, v136
    v_xor_b32 v65, s67, v137
    v_xor_b32 v66, s66, v138
    v_xor_b32 v67, s67, v139
    v_or3_b32 v72, v72, v64, v65
    v_or3_b32 v72, v72, v66, v67
    v_lshlrev_b32 v88, 16, v136
    v_and_b32 v89, 0xffff0000, v136
    v_lshlrev_b32 v90, 16, v137
    v_and_b32 v91, 0xffff0000, v137
    v_lshlrev_b32 v92, 16, v138
    v_and_b32 v93, 0xffff0000, v138
    v_lshlrev_b32 v94, 16, v139
    v_and_b32 v95, 0xffff0000, v139
    v_pk_add_f32 v[80:81], v[80:81], v[88:89]
    v_pk_add_f32 v[82:83], v[82:83], v[90:91]
    v_pk_add_f32 v[84:85], v[84:85], v[92:93]
    v_pk_add_f32 v[86:87], v[86:87], v[94:95]
    s_waitcnt vmcnt(0)
    v_xor_b32 v64, s66, v140
    v_xor_b32 v65, s67, v141
    v_xor_b32 v66, s66, v142
    v_xor_b32 v67, s67, v143
    v_or3_b32 v72, v72, v64, v65
    v_or3_b32 v72, v72, v66, v67
    v_lshlrev_b32 v88, 16, v140
    v_and_b32 v89, 0xffff0000, v140
    v_lshlrev_b32 v90, 16, v141
    v_and_b32 v91, 0xffff0000, v141
    v_lshlrev_b32 v92, 16, v142
    v_and_b32 v93, 0xffff0000, v142
    v_lshlrev_b32 v94, 16, v143
    v_and_b32 v95, 0xffff0000, v143
    v_pk_add_f32 v[80:81], v[80:81], v[88:89]
    v_pk_add_f32 v[82:83], v[82:83], v[90:91]
    v_pk_add_f32 v[84:85], v[84:85], v[92:93]
    v_pk_add_f32 v[86:87], v[86:87], v[94:95]
    v_and_b32 v72, v24, v72
    v_cmp_ne_u32 vcc, 0, v72
    s_cmp_lg_u64 vcc, 0
    s_cbranch_scc1 LAl_probe
LAl_sum:
    v_cvt_pk_bf16_f32 v88, v80, v81
    v_cvt_pk_bf16_f32 v89, v82, v83
    v_cvt_pk_bf16_f32 v90, v84, v85
    v_cvt_pk_bf16_f32 v91, v86, v87
    ds_write_b64 v18, v[88:89] offset:5632
    ds_write_b64 v19, v[88:89] offset:5632
    ds_write_b64 v20, v[90:91] offset:5632
    ds_write_b64 v21, v[90:91] offset:5632
    s_waitcnt lgkmcnt(0)
    s_barrier
    s_barrier
    s_cmp_eq_u32 s81, 7
    s_cbranch_scc1 L_end
    s_add_u32 m0, s100, 0
    s_nop 0
    buffer_load_dwordx4 v101, s[52:55], s83 offen lds
    s_add_u32 m0, s100, 4096
    s_nop 0
    buffer_load_dwordx4 v102, s[52:55], s83 offen lds
    s_add_u32 m0, s100, 8192
    s_nop 0
    buffer_load_dwordx4 v103, s[52:55], s83 offen lds
    s_add_u32 m0, s100, 12288
    s_nop 0
    buffer_load_dwordx4 v104, s[52:55], s83 offen lds
    s_add_u32 s83, s83, 102400
    s_cmp_ge_u32 s83, 819200
    s_cselect_b32 s83, 0, s83
    s_waitcnt vmcnt(0)
    s_barrier
    s_endpgm
L_Acomp:
    s_setprio 2
    v_and_b32 v14, 15, v1
    v_lshrrev_b32 v15, 4, v1
    v_and_b32 v12, 31, v1
    v_lshrrev_b32 v13, 5, v1
    v_min_u32 v3, 39, v1
    v_mul_u32_u24 v3, 40, v3
    s_cmp_eq_u32 s58, 1
    s_cselect_b32 s62, s57, s82
    s_mul_i32 s62, s62, 1600
    s_sub_u32 s63, s58, 1
    s_cmp_lt_u32 s63, 2
    s_cselect_b32 s65, s62, 1073741824
    s_waitcnt lgkmcnt(0)
    s_mov_b32 s36, s34
    s_and_b32 s37, s35, 0xffff
    s_mov_b32 s38, 17825792
    s_mov_b32 s39, 0x00020000
    v_mov_b32 v2, 0
    buffer_load_dword v250, v2, s[36:39], 0 offen sc1
    s_mov_b32 s52, s8
    s_and_b32 s53, s9, 0xffff
    s_mov_b32 s54, 25600
    s_mov_b32 s55, 0x00020000
    buffer_load_dwordx2 v[150:151], v3, s[52:55], s65 offen offset:0
    buffer_load_dwordx2 v[152:153], v3, s[52:55], s65 offen offset:8
    buffer_load_dwordx2 v[154:155], v3, s[52:55], s65 offen offset:16
    buffer_load_dwordx2 v[156:157], v3, s[52:55], s65 offen offset:24
    buffer_load_dwordx2 v[158:159], v3, s[52:55], s65 offen offset:32
    s_getpc_b64 s[78:79]
L_pcA:
    s_lshr_b32 s62, s2, 3
    s_lshl_b32 s62, s62, 2
    s_add_u32 s62, s62, s58
    s_mul_i32 s62, s62, 384
    v_min_u32 v2, 2, v1
    v_lshl_add_u32 v2, v2, 7, s62
    s_sub_u32 s78, s78, L_pcA-concat_heads__linear_kernel_hedgehog__ssm_conv_s5__prompt_kernel
    s_subb_u32 s79, s79, 0
    v_min_u32 v2, L_end-concat_heads__linear_kernel_hedgehog__ssm_conv_s5__prompt_kernel, v2
    global_load_dword v255, v2, s[78:79]
    v_bfe_u32 v2, v1, 1, 3
    v_xor_b32 v2, v2, v13
    v_lshlrev_b32 v2, 4, v2
    v_lshl_add_u32 v2, v12, 7, v2
    s_lshl_b32 s62, s58, 13
    v_add_u32 v240, s62, v2
    v_bfe_u32 v170, v1, 2, 2
    v_lshl_add_u32 v171, v13, 3, v170
    v_lshlrev_b32 v171, 8, v171
    v_and_b32 v172, 3, v1
    v_lshl_add_u32 v171, v172, 3, v171
    v_bfe_u32 v172, v1, 4, 1
    v_lshl_add_u32 v171, v172, 5, v171
    v_add_u32 v171, 32768, v171
    v_add_u32 v172, 0, v170
    v_and_b32 v172, 3, v172
    v_lshl_add_u32 v241, v172, 6, v171
    v_add_u32 v172, 1, v170
    v_and_b32 v172, 3, v172
    v_lshl_add_u32 v242, v172, 6, v171
    v_add_u32 v172, 2, v170
    v_and_b32 v172, 3, v172
    v_lshl_add_u32 v243, v172, 6, v171
    v_add_u32 v172, 3, v170
    v_and_b32 v172, 3, v172
    v_lshl_add_u32 v244, v172, 6, v171
    v_xor_b32 v4, 0, v240
    v_mov_b32 v8, v241
    v_xor_b32 v5, 32, v240
    v_mov_b32 v9, v242
    v_xor_b32 v6, 64, v240
    v_mov_b32 v10, v243
    v_xor_b32 v7, 96, v240
    v_mov_b32 v11, v244
    s_waitcnt vmcnt(1)
    v_readfirstlane_b32 s60, v250
    s_add_u32 s60, s60, 1
    s_mul_i32 s60, s60, 0x9e3779b1
    s_cmp_ge_u32 s63, 2
    s_cbranch_scc1 LA_nowp
    s_mul_i32 s62, s63, 2688
    v_mov_b32 v64, 0
    v_mov_b32 v65, 0
    v_mov_b32 v66, 0
    v_mov_b32 v67, 0
    v_lshl_add_u32 v68, v1, 4, s62
    ds_write_b128 v68, v[64:67] offset:0
    ds_write_b128 v68, v[64:67] offset:1024
    v_min_u32 v69, 39, v1
    v_lshl_add_u32 v68, v69, 4, s62
    ds_write_b128 v68, v[64:67] offset:2048
    v_add_u32 v65, 1, v69
    v_cmp_lt_u32 vcc, 19, v69
    s_nop 1
    v_cndmask_b32 v64, v69, v65, vcc
    v_lshl_add_u32 v64, v64, 6, s62
    ds_write2_b32 v64, v150, v151 offset0:0 offset1:1
    ds_write2_b32 v64, v152, v153 offset0:4 offset1:5
    ds_write2_b32 v64, v154, v155 offset0:8 offset1:2
    ds_write2_b32 v64, v156, v157 offset0:3 offset1:6
    ds_write2_b32 v64, v158, v159 offset0:7 offset1:10
    s_waitcnt lgkmcnt(0)
LA_nowp:
    v_mov_b32 v16, 0
    v_mov_b32 v17, 0
    v_mov_b32 v18, 0
    v_mov_b32 v19, 0
    v_mov_b32 v20, 0
    v_mov_b32 v21, 0
    v_mov_b32 v22, 0
    v_mov_b32 v23, 0
    v_mov_b32 v24, 0
    v_mov_b32 v25, 0
    v_mov_b32 v26, 0
    v_mov_b32 v27, 0
    v_mov_b32 v28, 0
    v_mov_b32 v29, 0
    v_mov_b32 v30, 0
    v_mov_b32 v31, 0
    v_mov_b32 v32, 0
    v_mov_b32 v33, 0
    v_mov_b32 v34, 0
    v_mov_b32 v35, 0
    v_mov_b32 v36, 0
    v_mov_b32 v37, 0
    v_mov_b32 v38, 0
    v_mov_b32 v39, 0
    v_mov_b32 v40, 0
    v_mov_b32 v41, 0
    v_mov_b32 v42, 0
    v_mov_b32 v43, 0
    v_mov_b32 v44, 0
    v_mov_b32 v45, 0
    v_mov_b32 v46, 0
    v_mov_b32 v47, 0
    v_mov_b32 v48, 0
    v_mov_b32 v49, 0
    v_mov_b32 v50, 0
    v_mov_b32 v51, 0
    v_mov_b32 v52, 0
    v_mov_b32 v53, 0
    v_mov_b32 v54, 0
    v_mov_b32 v55, 0
    v_mov_b32 v56, 0
    v_mov_b32 v57, 0
    v_mov_b32 v58, 0
    v_mov_b32 v59, 0
    v_mov_b32 v60, 0
    v_mov_b32 v61, 0
    v_mov_b32 v62, 0
    v_mov_b32 v63, 0
    v_mov_b32 v64, 0
    v_mov_b32 v65, 0
    v_mov_b32 v66, 0
    v_mov_b32 v67, 0
    v_mov_b32 v68, 0
    v_mov_b32 v69, 0
    v_mov_b32 v70, 0
    v_mov_b32 v71, 0
    v_mov_b32 v72, 0
    v_mov_b32 v73, 0
    v_mov_b32 v74, 0
    v_mov_b32 v75, 0
    v_mov_b32 v76, 0
    v_mov_b32 v77, 0
    v_mov_b32 v78, 0
    v_mov_b32 v79, 0
    v_mov_b32 v80, 0
    v_mov_b32 v81, 0
    v_mov_b32 v82, 0
    v_mov_b32 v83, 0
    v_mov_b32 v84, 0
    v_mov_b32 v85, 0
    v_mov_b32 v86, 0
    v_mov_b32 v87, 0
    v_mov_b32 v88, 0
    v_mov_b32 v89, 0
    v_mov_b32 v90, 0
    v_mov_b32 v91, 0
    v_mov_b32 v92, 0
    v_mov_b32 v93, 0
    v_mov_b32 v94, 0
    v_mov_b32 v95, 0
    v_mov_b32 v96, 0
    v_mov_b32 v97, 0
    v_mov_b32 v98, 0
    v_mov_b32 v99, 0
    v_mov_b32 v100, 0
    v_mov_b32 v101, 0
    v_mov_b32 v102, 0
    v_mov_b32 v103, 0
    v_mov_b32 v104, 0
    v_mov_b32 v105, 0
    v_mov_b32 v106, 0
    v_mov_b32 v107, 0
    v_mov_b32 v108, 0
    v_mov_b32 v109, 0
    v_mov_b32 v110, 0
    v_mov_b32 v111, 0
    v_mov_b32 v112, 0
    v_mov_b32 v113, 0
    v_mov_b32 v114, 0
    v_mov_b32 v115, 0
    v_mov_b32 v116, 0
    v_mov_b32 v117, 0
    v_mov_b32 v118, 0
    v_mov_b32 v119, 0
    v_mov_b32 v120, 0
    v_mov_b32 v121, 0
    v_mov_b32 v122, 0
    v_mov_b32 v123, 0
    v_mov_b32 v124, 0
    v_mov_b32 v125, 0
    v_mov_b32 v126, 0
    v_mov_b32 v127, 0
    v_mov_b32 v128, 0
    v_mov_b32 v129, 0
    v_mov_b32 v130, 0
    v_mov_b32 v131, 0
    v_mov_b32 v132, 0
    v_mov_b32 v133, 0
    v_mov_b32 v134, 0
    v_mov_b32 v135, 0
    v_mov_b32 v136, 0
    v_mov_b32 v137, 0
    v_mov_b32 v138, 0
    v_mov_b32 v139, 0
    v_mov_b32 v140, 0
    v_mov_b32 v141, 0
    v_mov_b32 v142, 0
    v_mov_b32 v143, 0
    s_mov_b32 s73, 0
    s_mov_b32 s74, 0
    s_barrier
    ds_read_b128 v[144:147], v4 offset:16384
    ds_read_b128 v[148:151], v4 offset:20480
    ds_read_b64_tr_b16 v[152:153], v8 offset:16384
    ds_read_b64_tr_b16 v[154:155], v8 offset:17408
    ds_read_b64_tr_b16 v[156:157], v9 offset:16384
    ds_read_b64_tr_b16 v[158:159], v9 offset:17408
    ds_read_b64_tr_b16 v[160:161], v10 offset:16384
    ds_read_b64_tr_b16 v[162:163], v10 offset:17408
    ds_read_b64_tr_b16 v[164:165], v11 offset:16384
    ds_read_b64_tr_b16 v[166:167], v11 offset:17408
.p2align 6
LA_loop:
    s_waitcnt lgkmcnt(0)
    v_mfma_f32_32x32x16_bf16 v[16:31], v[152:155], v[144:147], v[16:31]
    ds_read_b128 v[168:171], v5 offset:16384
    ds_read_b128 v[172:175], v5 offset:20480
    v_mfma_f32_32x32x16_bf16 v[80:95], v[152:155], v[148:151], v[80:95]
    ds_read_b64_tr_b16 v[176:177], v8 offset:20480
    ds_read_b64_tr_b16 v[178:179], v8 offset:21504
    v_mfma_f32_32x32x16_bf16 v[32:47], v[156:159], v[144:147], v[32:47]
    ds_read_b64_tr_b16 v[180:181], v9 offset:20480
    ds_read_b64_tr_b16 v[182:183], v9 offset:21504
    v_mfma_f32_32x32x16_bf16 v[96:111], v[156:159], v[148:151], v[96:111]
    ds_read_b64_tr_b16 v[184:185], v10 offset:20480
    ds_read_b64_tr_b16 v[186:187], v10 offset:21504
    v_mfma_f32_32x32x16_bf16 v[48:63], v[160:163], v[144:147], v[48:63]
    ds_read_b64_tr_b16 v[188:189], v11 offset:20480
    ds_read_b64_tr_b16 v[190:191], v11 offset:21504
    v_mfma_f32_32x32x16_bf16 v[112:127], v[160:163], v[148:151], v[112:127]
    v_mfma_f32_32x32x16_bf16 v[64:79], v[164:167], v[144:147], v[64:79]
    v_mfma_f32_32x32x16_bf16 v[128:143], v[164:167], v[148:151], v[128:143]
    s_waitcnt lgkmcnt(0)
    v_mfma_f32_32x32x16_bf16 v[16:31], v[176:179], v[168:171], v[16:31]
    ds_read_b128 v[144:147], v6 offset:16384
    ds_read_b128 v[148:151], v6 offset:20480
    v_mfma_f32_32x32x16_bf16 v[80:95], v[176:179], v[172:175], v[80:95]
    ds_read_b64_tr_b16 v[152:153], v8 offset:24576
    ds_read_b64_tr_b16 v[154:155], v8 offset:25600
    v_mfma_f32_32x32x16_bf16 v[32:47], v[180:183], v[168:171], v[32:47]
    ds_read_b64_tr_b16 v[156:157], v9 offset:24576
    ds_read_b64_tr_b16 v[158:159], v9 offset:25600
    v_mfma_f32_32x32x16_bf16 v[96:111], v[180:183], v[172:175], v[96:111]
    ds_read_b64_tr_b16 v[160:161], v10 offset:24576
    ds_read_b64_tr_b16 v[162:163], v10 offset:25600
    v_mfma_f32_32x32x16_bf16 v[48:63], v[184:187], v[168:171], v[48:63]
    ds_read_b64_tr_b16 v[164:165], v11 offset:24576
    ds_read_b64_tr_b16 v[166:167], v11 offset:25600
    v_mfma_f32_32x32x16_bf16 v[112:127], v[184:187], v[172:175], v[112:127]
    v_mfma_f32_32x32x16_bf16 v[64:79], v[188:191], v[168:171], v[64:79]
    v_mfma_f32_32x32x16_bf16 v[128:143], v[188:191], v[172:175], v[128:143]
    s_waitcnt lgkmcnt(0)
    s_add_u32 s73, s73, 49152
    s_cmp_ge_u32 s73, 147456
    s_cselect_b32 s73, 0, s73
    v_mfma_f32_32x32x16_bf16 v[16:31], v[152:155], v[144:147], v[16:31]
    ds_read_b128 v[168:171], v7 offset:16384
    ds_read_b128 v[172:175], v7 offset:20480
    v_mfma_f32_32x32x16_bf16 v[80:95], v[152:155], v[148:151], v[80:95]
    ds_read_b64_tr_b16 v[176:177], v8 offset:28672
    ds_read_b64_tr_b16 v[178:179], v8 offset:29696
    v_mfma_f32_32x32x16_bf16 v[32:47], v[156:159], v[144:147], v[32:47]
    ds_read_b64_tr_b16 v[180:181], v9 offset:28672
    ds_read_b64_tr_b16 v[182:183], v9 offset:29696
    v_mfma_f32_32x32x16_bf16 v[96:111], v[156:159], v[148:151], v[96:111]
    ds_read_b64_tr_b16 v[184:185], v10 offset:28672
    ds_read_b64_tr_b16 v[186:187], v10 offset:29696
    v_mfma_f32_32x32x16_bf16 v[48:63], v[160:163], v[144:147], v[48:63]
    ds_read_b64_tr_b16 v[188:189], v11 offset:28672
    ds_read_b64_tr_b16 v[190:191], v11 offset:29696
    v_mfma_f32_32x32x16_bf16 v[112:127], v[160:163], v[148:151], v[112:127]
    v_add_u32 v4, s73, v240
    v_xor_b32 v5, 32, v4
    v_xor_b32 v6, 64, v4
    v_mfma_f32_32x32x16_bf16 v[64:79], v[164:167], v[144:147], v[64:79]
    v_xor_b32 v7, 96, v4
    v_add_u32 v8, s73, v241
    v_add_u32 v9, s73, v242
    v_mfma_f32_32x32x16_bf16 v[128:143], v[164:167], v[148:151], v[128:143]
    v_add_u32 v10, s73, v243
    v_add_u32 v11, s73, v244
    s_waitcnt lgkmcnt(0)
    v_mfma_f32_32x32x16_bf16 v[16:31], v[176:179], v[168:171], v[16:31]
    v_mfma_f32_32x32x16_bf16 v[80:95], v[176:179], v[172:175], v[80:95]
    s_barrier
    v_mfma_f32_32x32x16_bf16 v[32:47], v[180:183], v[168:171], v[32:47]
    ds_read_b128 v[144:147], v4 offset:16384
    ds_read_b128 v[148:151], v4 offset:20480
    v_mfma_f32_32x32x16_bf16 v[96:111], v[180:183], v[172:175], v[96:111]
    ds_read_b64_tr_b16 v[152:153], v8 offset:16384
    ds_read_b64_tr_b16 v[154:155], v8 offset:17408
    v_mfma_f32_32x32x16_bf16 v[48:63], v[184:187], v[168:171], v[48:63]
    ds_read_b64_tr_b16 v[156:157], v9 offset:16384
    ds_read_b64_tr_b16 v[158:159], v9 offset:17408
    v_mfma_f32_32x32x16_bf16 v[112:127], v[184:187], v[172:175], v[112:127]
    ds_read_b64_tr_b16 v[160:161], v10 offset:16384
    ds_read_b64_tr_b16 v[162:163], v10 offset:17408
    v_mfma_f32_32x32x16_bf16 v[64:79], v[188:191], v[168:171], v[64:79]
    ds_read_b64_tr_b16 v[164:165], v11 offset:16384
    ds_read_b64_tr_b16 v[166:167], v11 offset:17408
    v_mfma_f32_32x32x16_bf16 v[128:143], v[188:191], v[172:175], v[128:143]
    s_add_u32 s74, s74, 1
    s_cmp_lt_u32 s74, 10
    s_cbranch_scc1 LA_loop
    v_bfe_u32 v7, v1, 2, 2
    v_and_b32 v8, 3, v1
    v_lshlrev_b32 v8, 3, v8
    v_bfe_u32 v9, v1, 4, 1
    v_lshl_add_u32 v8, v9, 5, v8
    v_lshl_add_u32 v4, v13, 2, v7
    v_lshl_add_u32 v4, v4, 6, v8
    v_add_u32 v9, 16, v7
    v_mov_b32 v2, 20
    v_cmp_lt_u32 vcc, 31, v1
    s_nop 1
    v_cndmask_b32 v5, v9, v2, vcc
    v_cndmask_b32 v6, v2, v7, vcc
    v_lshl_add_u32 v5, v5, 6, v8
    v_lshl_add_u32 v6, v6, 6, v8
    s_waitcnt lgkmcnt(0)
    ds_read_b64_tr_b16 v[208:209], v4 offset:0
    ds_read_b64_tr_b16 v[210:211], v4 offset:512
    ds_read_b64_tr_b16 v[212:213], v5 offset:0
    v_mov_b32 v214, 0
    v_mov_b32 v215, 0
    ds_read_b64_tr_b16 v[216:217], v6 offset:1344
    ds_read_b64_tr_b16 v[218:219], v4 offset:1600
    ds_read_b64_tr_b16 v[220:221], v4 offset:2112
    v_mov_b32 v222, 0
    v_mov_b32 v223, 0
    ds_read_b64_tr_b16 v[224:225], v4 offset:2688
    ds_read_b64_tr_b16 v[226:227], v4 offset:3200
    ds_read_b64_tr_b16 v[228:229], v5 offset:2688
    v_mov_b32 v230, 0
    v_mov_b32 v231, 0
    ds_read_b64_tr_b16 v[232:233], v6 offset:4032
    ds_read_b64_tr_b16 v[234:235], v4 offset:4288
    ds_read_b64_tr_b16 v[236:237], v4 offset:4800
    v_mov_b32 v238, 0
    v_mov_b32 v239, 0
    v_mul_u32_u24 v7, 264, v12
    s_mul_i32 s62, s58, 16896
    s_add_u32 s62, s62, 96240
    v_add_u32 v7, s62, v7
    v_lshl_add_u32 v8, v13, 3, v7
    v_lshl_add_u32 v10, v13, 4, v7
    v_mul_u32_u24 v2, 48, v13
    v_add_u32 v11, v7, v2
    v_mul_u32_u24 v2, 40, v13
    v_add_u32 v7, v7, v2
    v_cvt_pk_bf16_f32 v144, v16, v17
    v_cvt_pk_bf16_f32 v145, v18, v19
    v_cvt_pk_bf16_f32 v146, v20, v21
    v_cvt_pk_bf16_f32 v147, v22, v23
    v_cvt_pk_bf16_f32 v148, v24, v25
    v_cvt_pk_bf16_f32 v149, v26, v27
    v_cvt_pk_bf16_f32 v150, v28, v29
    v_cvt_pk_bf16_f32 v151, v30, v31
    v_cvt_pk_bf16_f32 v152, v32, v33
    v_cvt_pk_bf16_f32 v153, v34, v35
    v_cvt_pk_bf16_f32 v154, v36, v37
    v_cvt_pk_bf16_f32 v155, v38, v39
    v_cvt_pk_bf16_f32 v156, v40, v41
    v_cvt_pk_bf16_f32 v157, v42, v43
    v_cvt_pk_bf16_f32 v158, v44, v45
    v_cvt_pk_bf16_f32 v159, v46, v47
    v_cvt_pk_bf16_f32 v160, v48, v49
    v_cvt_pk_bf16_f32 v161, v50, v51
    v_cvt_pk_bf16_f32 v162, v52, v53
    v_cvt_pk_bf16_f32 v163, v54, v55
    v_cvt_pk_bf16_f32 v164, v56, v57
    v_cvt_pk_bf16_f32 v165, v58, v59
    v_cvt_pk_bf16_f32 v166, v60, v61
    v_cvt_pk_bf16_f32 v167, v62, v63
    v_cvt_pk_bf16_f32 v168, v64, v65
    v_cvt_pk_bf16_f32 v169, v66, v67
    v_cvt_pk_bf16_f32 v170, v68, v69
    v_cvt_pk_bf16_f32 v171, v70, v71
    v_cvt_pk_bf16_f32 v172, v72, v73
    v_cvt_pk_bf16_f32 v173, v74, v75
    v_mov_b32 v174, 0x3f80
    v_mov_b32 v175, 0
    s_waitcnt lgkmcnt(0)
    v_mfma_f32_32x32x16_bf16 v[16:31], v[208:211], v[154:157], 0
    v_mfma_f32_32x32x16_bf16 v[32:47], v[216:219], v[158:161], 0
    v_mfma_f32_32x32x16_bf16 v[16:31], v[212:215], v[158:161], v[16:31]
    v_mfma_f32_32x32x16_bf16 v[32:47], v[220:223], v[162:165], v[32:47]
    v_mfma_f32_32x32x16_bf16 v[48:63], v[224:227], v[144:147], 0
    v_mfma_f32_32x32x16_bf16 v[64:79], v[232:235], v[148:151], 0
    ds_write_b64 v8, v[164:165] offset:160
    ds_write_b64 v8, v[166:167] offset:176
    ds_write_b64 v10, v[168:169] offset:192
    v_mfma_f32_32x32x16_bf16 v[48:63], v[228:231], v[148:151], v[48:63]
    v_mfma_f32_32x32x16_bf16 v[64:79], v[236:239], v[152:155], v[64:79]
    ds_write_b64 v8, v[170:171] offset:216
    ds_write_b64 v8, v[172:173] offset:232
    ds_write_b64 v11, v[174:175] offset:200
    v_cvt_pk_bf16_f32 v176, v80, v81
    v_cvt_pk_bf16_f32 v177, v82, v83
    v_cvt_pk_bf16_f32 v178, v84, v85
    v_cvt_pk_bf16_f32 v179, v86, v87
    v_cvt_pk_bf16_f32 v180, v88, v89
    v_cvt_pk_bf16_f32 v181, v90, v91
    v_cvt_pk_bf16_f32 v182, v92, v93
    v_cvt_pk_bf16_f32 v183, v94, v95
    v_cvt_pk_bf16_f32 v184, v96, v97
    v_cvt_pk_bf16_f32 v185, v98, v99
    v_cvt_pk_bf16_f32 v186, v100, v101
    v_cvt_pk_bf16_f32 v187, v102, v103
    v_cvt_pk_bf16_f32 v188, v104, v105
    v_cvt_pk_bf16_f32 v189, v106, v107
    v_cvt_pk_bf16_f32 v190, v108, v109
    v_cvt_pk_bf16_f32 v191, v110, v111
    v_cvt_pk_bf16_f32 v192, v112, v113
    v_cvt_pk_bf16_f32 v193, v114, v115
    v_cvt_pk_bf16_f32 v194, v116, v117
    v_cvt_pk_bf16_f32 v195, v118, v119
    v_cvt_pk_bf16_f32 v196, v120, v121
    v_cvt_pk_bf16_f32 v197, v122, v123
    v_cvt_pk_bf16_f32 v198, v124, v125
    v_cvt_pk_bf16_f32 v199, v126, v127
    v_cvt_pk_bf16_f32 v200, v128, v129
    v_cvt_pk_bf16_f32 v201, v130, v131
    v_cvt_pk_bf16_f32 v202, v132, v133
    v_cvt_pk_bf16_f32 v203, v134, v135
    v_cvt_pk_bf16_f32 v204, v136, v137
    v_cvt_pk_bf16_f32 v205, v138, v139
    v_mov_b32 v206, 0x3f80
    v_mov_b32 v207, 0
    v_mfma_f32_32x32x16_bf16 v[80:95], v[208:211], v[186:189], 0
    v_mfma_f32_32x32x16_bf16 v[96:111], v[216:219], v[190:193], 0
    v_mfma_f32_32x32x16_bf16 v[80:95], v[212:215], v[190:193], v[80:95]
    v_mfma_f32_32x32x16_bf16 v[96:111], v[220:223], v[194:197], v[96:111]
    v_mfma_f32_32x32x16_bf16 v[112:127], v[224:227], v[176:179], 0
    v_mfma_f32_32x32x16_bf16 v[128:143], v[232:235], v[180:183], 0
    ds_write_b64 v8, v[196:197] offset:8608
    ds_write_b64 v8, v[198:199] offset:8624
    ds_write_b64 v10, v[200:201] offset:8640
    v_mfma_f32_32x32x16_bf16 v[112:127], v[228:231], v[180:183], v[112:127]
    v_mfma_f32_32x32x16_bf16 v[128:143], v[236:239], v[184:187], v[128:143]
    ds_write_b64 v8, v[202:203] offset:8664
    ds_write_b64 v8, v[204:205] offset:8680
    ds_write_b64 v11, v[206:207] offset:8648
    v_max3_f32 v248, v16, v17, v18
    v_max3_f32 v249, -v16, -v17, -v18
    v_max3_f32 v248, v248, v19, v20
    v_max3_f32 v249, v249, -v19, -v20
    v_max3_f32 v248, v248, v21, v22
    v_max3_f32 v249, v249, -v21, -v22
    v_max3_f32 v248, v248, v23, v24
    v_max3_f32 v249, v249, -v23, -v24
    v_max_f32 v248, v248, v25
    v_max_f32_e64 v249, v249, -v25
    v_max3_f32 v252, v32, v33, v34
    v_max3_f32 v253, -v32, -v33, -v34
    v_max3_f32 v252, v252, v35, v36
    v_max3_f32 v253, v253, -v35, -v36
    v_max3_f32 v252, v252, v37, v38
    v_max3_f32 v253, v253, -v37, -v38
    v_max3_f32 v252, v252, v39, v40
    v_max3_f32 v253, v253, -v39, -v40
    v_max_f32 v252, v252, v41
    v_max_f32_e64 v253, v253, -v41
    v_permlane32_swap_b32 v248, v249
    s_nop 0
    v_permlane32_swap_b32 v252, v253
    v_max_f32 v248, v248, v249
    v_max_f32 v252, v252, v253
    v_mov_b32 v249, v248
    v_mov_b32 v253, v252
    s_nop 0
    v_permlane32_swap_b32 v248, v249
    v_permlane32_swap_b32 v252, v253
    v_pk_mul_f32 v[250:251], v[248:249], s[76:77] neg_lo:[0,1] neg_hi:[0,1]
    v_pk_mul_f32 v[254:255], v[252:253], s[76:77] neg_lo:[0,1] neg_hi:[0,1]
    v_pk_fma_f32 v[208:209], v[16:17], s[76:77], v[250:251] op_sel:[0,0,0] op_sel_hi:[1,1,0]
    v_pk_fma_f32 v[218:219], v[16:17], s[76:77], v[250:251] op_sel:[0,0,1] op_sel_hi:[1,1,1] neg_lo:[0,1,0] neg_hi:[0,1,0]
    v_pk_fma_f32 v[228:229], v[32:33], s[76:77], v[254:255] op_sel:[0,0,0] op_sel_hi:[1,1,0]
    v_pk_fma_f32 v[238:239], v[32:33], s[76:77], v[254:255] op_sel:[0,0,1] op_sel_hi:[1,1,1] neg_lo:[0,1,0] neg_hi:[0,1,0]
    v_pk_fma_f32 v[210:211], v[18:19], s[76:77], v[250:251] op_sel:[0,0,0] op_sel_hi:[1,1,0]
    v_pk_fma_f32 v[220:221], v[18:19], s[76:77], v[250:251] op_sel:[0,0,1] op_sel_hi:[1,1,1] neg_lo:[0,1,0] neg_hi:[0,1,0]
    v_pk_fma_f32 v[230:231], v[34:35], s[76:77], v[254:255] op_sel:[0,0,0] op_sel_hi:[1,1,0]
    v_pk_fma_f32 v[240:241], v[34:35], s[76:77], v[254:255] op_sel:[0,0,1] op_sel_hi:[1,1,1] neg_lo:[0,1,0] neg_hi:[0,1,0]
    v_pk_fma_f32 v[212:213], v[20:21], s[76:77], v[250:251] op_sel:[0,0,0] op_sel_hi:[1,1,0]
    v_pk_fma_f32 v[222:223], v[20:21], s[76:77], v[250:251] op_sel:[0,0,1] op_sel_hi:[1,1,1] neg_lo:[0,1,0] neg_hi:[0,1,0]
    v_pk_fma_f32 v[232:233], v[36:37], s[76:77], v[254:255] op_sel:[0,0,0] op_sel_hi:[1,1,0]
    v_pk_fma_f32 v[242:243], v[36:37], s[76:77], v[254:255] op_sel:[0,0,1] op_sel_hi:[1,1,1] neg_lo:[0,1,0] neg_hi:[0,1,0]
    v_pk_fma_f32 v[214:215], v[22:23], s[76:77], v[250:251] op_sel:[0,0,0] op_sel_hi:[1,1,0]
    v_pk_fma_f32 v[224:225], v[22:23], s[76:77], v[250:251] op_sel:[0,0,1] op_sel_hi:[1,1,1] neg_lo:[0,1,0] neg_hi:[0,1,0]
    v_pk_fma_f32 v[234:235], v[38:39], s[76:77], v[254:255] op_sel:[0,0,0] op_sel_hi:[1,1,0]
    v_pk_fma_f32 v[244:245], v[38:39], s[76:77], v[254:255] op_sel:[0,0,1] op_sel_hi:[1,1,1] neg_lo:[0,1,0] neg_hi:[0,1,0]
    v_pk_fma_f32 v[216:217], v[24:25], s[76:77], v[250:251] op_sel:[0,0,0] op_sel_hi:[1,1,0]
    v_pk_fma_f32 v[226:227], v[24:25], s[76:77], v[250:251] op_sel:[0,0,1] op_sel_hi:[1,1,1] neg_lo:[0,1,0] neg_hi:[0,1,0]
    v_pk_fma_f32 v[236:237], v[40:41], s[76:77], v[254:255] op_sel:[0,0,0] op_sel_hi:[1,1,0]
    v_pk_fma_f32 v[246:247], v[40:41], s[76:77], v[254:255] op_sel:[0,0,1] op_sel_hi:[1,1,1] neg_lo:[0,1,0] neg_hi:[0,1,0]
    v_exp_f32 v208, v208
    v_exp_f32 v228, v228
    v_exp_f32 v209, v209
    v_exp_f32 v229, v229
    v_exp_f32 v210, v210
    v_exp_f32 v230, v230
    v_exp_f32 v211, v211
    v_exp_f32 v231, v231
    v_exp_f32 v212, v212
    v_exp_f32 v232, v232
    v_exp_f32 v213, v213
    v_exp_f32 v233, v233
    v_exp_f32 v214, v214
    v_exp_f32 v234, v234
    v_exp_f32 v215, v215
    v_exp_f32 v235, v235
    v_exp_f32 v216, v216
    v_exp_f32 v236, v236
    v_exp_f32 v217, v217
    v_exp_f32 v237, v237
    v_exp_f32 v218, v218
    v_exp_f32 v238, v238
    v_exp_f32 v219, v219
    v_exp_f32 v239, v239
    v_exp_f32 v220, v220
    v_exp_f32 v240, v240
    v_exp_f32 v221, v221
    v_exp_f32 v241, v241
    v_exp_f32 v222, v222
    v_exp_f32 v242, v242
    v_exp_f32 v223, v223
    v_exp_f32 v243, v243
    v_exp_f32 v224, v224
    v_exp_f32 v244, v244
    v_exp_f32 v225, v225
    v_exp_f32 v245, v245
    v_exp_f32 v226, v226
    v_exp_f32 v246, v246
    v_exp_f32 v227, v227
    v_exp_f32 v247, v247
    v_pk_add_f32 v[248:249], v[208:209], v[210:211]
    v_pk_add_f32 v[250:251], v[218:219], v[220:221]
    v_pk_add_f32 v[252:253], v[228:229], v[230:231]
    v_pk_add_f32 v[254:255], v[238:239], v[240:241]
    v_pk_add_f32 v[248:249], v[248:249], v[212:213]
    v_pk_add_f32 v[250:251], v[250:251], v[222:223]
    v_pk_add_f32 v[252:253], v[252:253], v[232:233]
    v_pk_add_f32 v[254:255], v[254:255], v[242:243]
    v_pk_add_f32 v[248:249], v[248:249], v[214:215]
    v_pk_add_f32 v[250:251], v[250:251], v[224:225]
    v_pk_add_f32 v[252:253], v[252:253], v[234:235]
    v_pk_add_f32 v[254:255], v[254:255], v[244:245]
    v_pk_add_f32 v[248:249], v[248:249], v[216:217]
    v_pk_add_f32 v[250:251], v[250:251], v[226:227]
    v_pk_add_f32 v[252:253], v[252:253], v[236:237]
    v_pk_add_f32 v[254:255], v[254:255], v[246:247]
    v_add_f32 v248, v248, v249
    v_add_f32 v249, v250, v251
    v_add_f32 v252, v252, v253
    v_add_f32 v253, v254, v255
    v_permlane32_swap_b32 v248, v249
    s_nop 0
    v_permlane32_swap_b32 v252, v253
    v_add_f32 v248, v248, v249
    v_add_f32 v252, v252, v253
    v_rcp_f32 v248, v248
    v_rcp_f32 v252, v252
    v_mov_b32 v249, v248
    v_mov_b32 v253, v252
    s_nop 0
    v_permlane32_swap_b32 v248, v249
    v_permlane32_swap_b32 v252, v253
    v_pk_mul_f32 v[208:209], v[208:209], v[248:249] op_sel:[0,0] op_sel_hi:[1,0]
    v_pk_mul_f32 v[218:219], v[218:219], v[248:249] op_sel:[0,1] op_sel_hi:[1,1]
    v_pk_mul_f32 v[228:229], v[228:229], v[252:253] op_sel:[0,0] op_sel_hi:[1,0]
    v_pk_mul_f32 v[238:239], v[238:239], v[252:253] op_sel:[0,1] op_sel_hi:[1,1]
    v_pk_mul_f32 v[210:211], v[210:211], v[248:249] op_sel:[0,0] op_sel_hi:[1,0]
    v_pk_mul_f32 v[220:221], v[220:221], v[248:249] op_sel:[0,1] op_sel_hi:[1,1]
    v_pk_mul_f32 v[230:231], v[230:231], v[252:253] op_sel:[0,0] op_sel_hi:[1,0]
    v_pk_mul_f32 v[240:241], v[240:241], v[252:253] op_sel:[0,1] op_sel_hi:[1,1]
    v_pk_mul_f32 v[212:213], v[212:213], v[248:249] op_sel:[0,0] op_sel_hi:[1,0]
    v_pk_mul_f32 v[222:223], v[222:223], v[248:249] op_sel:[0,1] op_sel_hi:[1,1]
    v_pk_mul_f32 v[232:233], v[232:233], v[252:253] op_sel:[0,0] op_sel_hi:[1,0]
    v_pk_mul_f32 v[242:243], v[242:243], v[252:253] op_sel:[0,1] op_sel_hi:[1,1]
    v_pk_mul_f32 v[214:215], v[214:215], v[248:249] op_sel:[0,0] op_sel_hi:[1,0]
    v_pk_mul_f32 v[224:225], v[224:225], v[248:249] op_sel:[0,1] op_sel_hi:[1,1]
    v_pk_mul_f32 v[234:235], v[234:235], v[252:253] op_sel:[0,0] op_sel_hi:[1,0]
    v_pk_mul_f32 v[244:245], v[244:245], v[252:253] op_sel:[0,1] op_sel_hi:[1,1]
    v_pk_mul_f32 v[216:217], v[216:217], v[248:249] op_sel:[0,0] op_sel_hi:[1,0]
    v_pk_mul_f32 v[226:227], v[226:227], v[248:249] op_sel:[0,1] op_sel_hi:[1,1]
    v_pk_mul_f32 v[236:237], v[236:237], v[252:253] op_sel:[0,0] op_sel_hi:[1,0]
    v_pk_mul_f32 v[246:247], v[246:247], v[252:253] op_sel:[0,1] op_sel_hi:[1,1]
    v_cvt_pk_bf16_f32 v144, v208, v209
    v_cvt_pk_bf16_f32 v160, v228, v229
    v_cvt_pk_bf16_f32 v145, v210, v211
    v_cvt_pk_bf16_f32 v161, v230, v231
    v_cvt_pk_bf16_f32 v146, v212, v213
    v_cvt_pk_bf16_f32 v162, v232, v233
    v_cvt_pk_bf16_f32 v147, v214, v215
    v_cvt_pk_bf16_f32 v163, v234, v235
    v_cvt_pk_bf16_f32 v148, v216, v217
    v_cvt_pk_bf16_f32 v164, v236, v237
    v_cvt_pk_bf16_f32 v149, v218, v219
    v_cvt_pk_bf16_f32 v165, v238, v239
    v_cvt_pk_bf16_f32 v150, v220, v221
    v_cvt_pk_bf16_f32 v166, v240, v241
    v_cvt_pk_bf16_f32 v151, v222, v223
    v_cvt_pk_bf16_f32 v167, v242, v243
    v_cvt_pk_bf16_f32 v152, v224, v225
    v_cvt_pk_bf16_f32 v168, v244, v245
    v_cvt_pk_bf16_f32 v153, v226, v227
    v_cvt_pk_bf16_f32 v169, v246, v247
    ds_write_b64 v7, v[144:145] offset:0
    ds_write_b64 v7, v[146:147] offset:8
    ds_write_b64 v7, v[148:149] offset:16
    ds_write_b64 v7, v[150:151] offset:24
    ds_write_b64 v7, v[152:153] offset:32
    ds_write_b64 v7, v[160:161] offset:80
    ds_write_b64 v7, v[162:163] offset:88
    ds_write_b64 v7, v[164:165] offset:96
    ds_write_b64 v7, v[166:167] offset:104
    ds_write_b64 v7, v[168:169] offset:112
    v_max3_f32 v248, v80, v81, v82
    v_max3_f32 v249, -v80, -v81, -v82
    v_max3_f32 v248, v248, v83, v84
    v_max3_f32 v249, v249, -v83, -v84
    v_max3_f32 v248, v248, v85, v86
    v_max3_f32 v249, v249, -v85, -v86
    v_max3_f32 v248, v248, v87, v88
    v_max3_f32 v249, v249, -v87, -v88
    v_max_f32 v248, v248, v89
    v_max_f32_e64 v249, v249, -v89
    v_max3_f32 v252, v96, v97, v98
    v_max3_f32 v253, -v96, -v97, -v98
    v_max3_f32 v252, v252, v99, v100
    v_max3_f32 v253, v253, -v99, -v100
    v_max3_f32 v252, v252, v101, v102
    v_max3_f32 v253, v253, -v101, -v102
    v_max3_f32 v252, v252, v103, v104
    v_max3_f32 v253, v253, -v103, -v104
    v_max_f32 v252, v252, v105
    v_max_f32_e64 v253, v253, -v105
    v_permlane32_swap_b32 v248, v249
    s_nop 0
    v_permlane32_swap_b32 v252, v253
    v_max_f32 v248, v248, v249
    v_max_f32 v252, v252, v253
    v_mov_b32 v249, v248
    v_mov_b32 v253, v252
    s_nop 0
    v_permlane32_swap_b32 v248, v249
    v_permlane32_swap_b32 v252, v253
    v_pk_mul_f32 v[250:251], v[248:249], s[76:77] neg_lo:[0,1] neg_hi:[0,1]
    v_pk_mul_f32 v[254:255], v[252:253], s[76:77] neg_lo:[0,1] neg_hi:[0,1]
    v_pk_fma_f32 v[208:209], v[80:81], s[76:77], v[250:251] op_sel:[0,0,0] op_sel_hi:[1,1,0]
    v_pk_fma_f32 v[218:219], v[80:81], s[76:77], v[250:251] op_sel:[0,0,1] op_sel_hi:[1,1,1] neg_lo:[0,1,0] neg_hi:[0,1,0]
    v_pk_fma_f32 v[228:229], v[96:97], s[76:77], v[254:255] op_sel:[0,0,0] op_sel_hi:[1,1,0]
    v_pk_fma_f32 v[238:239], v[96:97], s[76:77], v[254:255] op_sel:[0,0,1] op_sel_hi:[1,1,1] neg_lo:[0,1,0] neg_hi:[0,1,0]
    v_pk_fma_f32 v[210:211], v[82:83], s[76:77], v[250:251] op_sel:[0,0,0] op_sel_hi:[1,1,0]
    v_pk_fma_f32 v[220:221], v[82:83], s[76:77], v[250:251] op_sel:[0,0,1] op_sel_hi:[1,1,1] neg_lo:[0,1,0] neg_hi:[0,1,0]
    v_pk_fma_f32 v[230:231], v[98:99], s[76:77], v[254:255] op_sel:[0,0,0] op_sel_hi:[1,1,0]
    v_pk_fma_f32 v[240:241], v[98:99], s[76:77], v[254:255] op_sel:[0,0,1] op_sel_hi:[1,1,1] neg_lo:[0,1,0] neg_hi:[0,1,0]
    v_pk_fma_f32 v[212:213], v[84:85], s[76:77], v[250:251] op_sel:[0,0,0] op_sel_hi:[1,1,0]
    v_pk_fma_f32 v[222:223], v[84:85], s[76:77], v[250:251] op_sel:[0,0,1] op_sel_hi:[1,1,1] neg_lo:[0,1,0] neg_hi:[0,1,0]
    v_pk_fma_f32 v[232:233], v[100:101], s[76:77], v[254:255] op_sel:[0,0,0] op_sel_hi:[1,1,0]
    v_pk_fma_f32 v[242:243], v[100:101], s[76:77], v[254:255] op_sel:[0,0,1] op_sel_hi:[1,1,1] neg_lo:[0,1,0] neg_hi:[0,1,0]
    v_pk_fma_f32 v[214:215], v[86:87], s[76:77], v[250:251] op_sel:[0,0,0] op_sel_hi:[1,1,0]
    v_pk_fma_f32 v[224:225], v[86:87], s[76:77], v[250:251] op_sel:[0,0,1] op_sel_hi:[1,1,1] neg_lo:[0,1,0] neg_hi:[0,1,0]
    v_pk_fma_f32 v[234:235], v[102:103], s[76:77], v[254:255] op_sel:[0,0,0] op_sel_hi:[1,1,0]
    v_pk_fma_f32 v[244:245], v[102:103], s[76:77], v[254:255] op_sel:[0,0,1] op_sel_hi:[1,1,1] neg_lo:[0,1,0] neg_hi:[0,1,0]
    v_pk_fma_f32 v[216:217], v[88:89], s[76:77], v[250:251] op_sel:[0,0,0] op_sel_hi:[1,1,0]
    v_pk_fma_f32 v[226:227], v[88:89], s[76:77], v[250:251] op_sel:[0,0,1] op_sel_hi:[1,1,1] neg_lo:[0,1,0] neg_hi:[0,1,0]
    v_pk_fma_f32 v[236:237], v[104:105], s[76:77], v[254:255] op_sel:[0,0,0] op_sel_hi:[1,1,0]
    v_pk_fma_f32 v[246:247], v[104:105], s[76:77], v[254:255] op_sel:[0,0,1] op_sel_hi:[1,1,1] neg_lo:[0,1,0] neg_hi:[0,1,0]
    v_exp_f32 v208, v208
    v_exp_f32 v228, v228
    v_exp_f32 v209, v209
    v_exp_f32 v229, v229
    v_exp_f32 v210, v210
    v_exp_f32 v230, v230
    v_exp_f32 v211, v211
    v_exp_f32 v231, v231
    v_exp_f32 v212, v212
    v_exp_f32 v232, v232
    v_exp_f32 v213, v213
    v_exp_f32 v233, v233
    v_exp_f32 v214, v214
    v_exp_f32 v234, v234
    v_exp_f32 v215, v215
    v_exp_f32 v235, v235
    v_exp_f32 v216, v216
    v_exp_f32 v236, v236
    v_exp_f32 v217, v217
    v_exp_f32 v237, v237
    v_exp_f32 v218, v218
    v_exp_f32 v238, v238
    v_exp_f32 v219, v219
    v_exp_f32 v239, v239
    v_exp_f32 v220, v220
    v_exp_f32 v240, v240
    v_exp_f32 v221, v221
    v_exp_f32 v241, v241
    v_exp_f32 v222, v222
    v_exp_f32 v242, v242
    v_exp_f32 v223, v223
    v_exp_f32 v243, v243
    v_exp_f32 v224, v224
    v_exp_f32 v244, v244
    v_exp_f32 v225, v225
    v_exp_f32 v245, v245
    v_exp_f32 v226, v226
    v_exp_f32 v246, v246
    v_exp_f32 v227, v227
    v_exp_f32 v247, v247
    v_pk_add_f32 v[248:249], v[208:209], v[210:211]
    v_pk_add_f32 v[250:251], v[218:219], v[220:221]
    v_pk_add_f32 v[252:253], v[228:229], v[230:231]
    v_pk_add_f32 v[254:255], v[238:239], v[240:241]
    v_pk_add_f32 v[248:249], v[248:249], v[212:213]
    v_pk_add_f32 v[250:251], v[250:251], v[222:223]
    v_pk_add_f32 v[252:253], v[252:253], v[232:233]
    v_pk_add_f32 v[254:255], v[254:255], v[242:243]
    v_pk_add_f32 v[248:249], v[248:249], v[214:215]
    v_pk_add_f32 v[250:251], v[250:251], v[224:225]
    v_pk_add_f32 v[252:253], v[252:253], v[234:235]
    v_pk_add_f32 v[254:255], v[254:255], v[244:245]
    v_pk_add_f32 v[248:249], v[248:249], v[216:217]
    v_pk_add_f32 v[250:251], v[250:251], v[226:227]
    v_pk_add_f32 v[252:253], v[252:253], v[236:237]
    v_pk_add_f32 v[254:255], v[254:255], v[246:247]
    v_add_f32 v248, v248, v249
    v_add_f32 v249, v250, v251
    v_add_f32 v252, v252, v253
    v_add_f32 v253, v254, v255
    v_permlane32_swap_b32 v248, v249
    s_nop 0
    v_permlane32_swap_b32 v252, v253
    v_add_f32 v248, v248, v249
    v_add_f32 v252, v252, v253
    v_rcp_f32 v248, v248
    v_rcp_f32 v252, v252
    v_mov_b32 v249, v248
    v_mov_b32 v253, v252
    s_nop 0
    v_permlane32_swap_b32 v248, v249
    v_permlane32_swap_b32 v252, v253
    v_pk_mul_f32 v[208:209], v[208:209], v[248:249] op_sel:[0,0] op_sel_hi:[1,0]
    v_pk_mul_f32 v[218:219], v[218:219], v[248:249] op_sel:[0,1] op_sel_hi:[1,1]
    v_pk_mul_f32 v[228:229], v[228:229], v[252:253] op_sel:[0,0] op_sel_hi:[1,0]
    v_pk_mul_f32 v[238:239], v[238:239], v[252:253] op_sel:[0,1] op_sel_hi:[1,1]
    v_pk_mul_f32 v[210:211], v[210:211], v[248:249] op_sel:[0,0] op_sel_hi:[1,0]
    v_pk_mul_f32 v[220:221], v[220:221], v[248:249] op_sel:[0,1] op_sel_hi:[1,1]
    v_pk_mul_f32 v[230:231], v[230:231], v[252:253] op_sel:[0,0] op_sel_hi:[1,0]
    v_pk_mul_f32 v[240:241], v[240:241], v[252:253] op_sel:[0,1] op_sel_hi:[1,1]
    v_pk_mul_f32 v[212:213], v[212:213], v[248:249] op_sel:[0,0] op_sel_hi:[1,0]
    v_pk_mul_f32 v[222:223], v[222:223], v[248:249] op_sel:[0,1] op_sel_hi:[1,1]
    v_pk_mul_f32 v[232:233], v[232:233], v[252:253] op_sel:[0,0] op_sel_hi:[1,0]
    v_pk_mul_f32 v[242:243], v[242:243], v[252:253] op_sel:[0,1] op_sel_hi:[1,1]
    v_pk_mul_f32 v[214:215], v[214:215], v[248:249] op_sel:[0,0] op_sel_hi:[1,0]
    v_pk_mul_f32 v[224:225], v[224:225], v[248:249] op_sel:[0,1] op_sel_hi:[1,1]
    v_pk_mul_f32 v[234:235], v[234:235], v[252:253] op_sel:[0,0] op_sel_hi:[1,0]
    v_pk_mul_f32 v[244:245], v[244:245], v[252:253] op_sel:[0,1] op_sel_hi:[1,1]
    v_pk_mul_f32 v[216:217], v[216:217], v[248:249] op_sel:[0,0] op_sel_hi:[1,0]
    v_pk_mul_f32 v[226:227], v[226:227], v[248:249] op_sel:[0,1] op_sel_hi:[1,1]
    v_pk_mul_f32 v[236:237], v[236:237], v[252:253] op_sel:[0,0] op_sel_hi:[1,0]
    v_pk_mul_f32 v[246:247], v[246:247], v[252:253] op_sel:[0,1] op_sel_hi:[1,1]
    v_cvt_pk_bf16_f32 v176, v208, v209
    v_cvt_pk_bf16_f32 v192, v228, v229
    v_cvt_pk_bf16_f32 v177, v210, v211
    v_cvt_pk_bf16_f32 v193, v230, v231
    v_cvt_pk_bf16_f32 v178, v212, v213
    v_cvt_pk_bf16_f32 v194, v232, v233
    v_cvt_pk_bf16_f32 v179, v214, v215
    v_cvt_pk_bf16_f32 v195, v234, v235
    v_cvt_pk_bf16_f32 v180, v216, v217
    v_cvt_pk_bf16_f32 v196, v236, v237
    v_cvt_pk_bf16_f32 v181, v218, v219
    v_cvt_pk_bf16_f32 v197, v238, v239
    v_cvt_pk_bf16_f32 v182, v220, v221
    v_cvt_pk_bf16_f32 v198, v240, v241
    v_cvt_pk_bf16_f32 v183, v222, v223
    v_cvt_pk_bf16_f32 v199, v242, v243
    v_cvt_pk_bf16_f32 v184, v224, v225
    v_cvt_pk_bf16_f32 v200, v244, v245
    v_cvt_pk_bf16_f32 v185, v226, v227
    v_cvt_pk_bf16_f32 v201, v246, v247
    ds_write_b64 v7, v[176:177] offset:8448
    ds_write_b64 v7, v[178:179] offset:8456
    ds_write_b64 v7, v[180:181] offset:8464
    ds_write_b64 v7, v[182:183] offset:8472
    ds_write_b64 v7, v[184:185] offset:8480
    ds_write_b64 v7, v[192:193] offset:8528
    ds_write_b64 v7, v[194:195] offset:8536
    ds_write_b64 v7, v[196:197] offset:8544
    ds_write_b64 v7, v[198:199] offset:8552
    ds_write_b64 v7, v[200:201] offset:8560
    v_and_b32 v2, 1, v15
    v_lshlrev_b32 v2, 4, v2
    v_bfe_u32 v3, v1, 2, 2
    v_lshl_add_u32 v2, v3, 2, v2
    v_lshl_add_u32 v2, v13, 1, v2
    v_mul_u32_u24 v2, 264, v2
    v_and_b32 v3, 3, v1
    v_lshl_add_u32 v2, v3, 3, v2
    s_lshr_b32 s62, s58, 1
    s_and_b32 s63, s58, 1
    s_mul_i32 s64, s62, 80
    s_add_u32 s64, s64, 96240
    v_add_u32 v6, s64, v2
    s_mul_i32 s64, s62, 48
    s_lshl_b32 s65, s63, 5
    s_add_u32 s64, s64, s65
    s_add_u32 s64, s64, 96400
    v_add_u32 v4, s64, v2
    s_lshl_b32 s64, s57, 3
    s_add_u32 s64, s64, s56
    s_mul_i32 s64, s64, 3584
    s_mul_i32 s65, s62, 1680
    s_add_u32 s64, s64, s65
    s_add_u32 s64, s64, 5242880
    s_lshl_b32 s65, s63, 4
    v_add_u32 v2, s65, v14
    v_mul_u32_u24 v3, 21, v15
    v_add_u32 v3, v3, v2
    v_lshl_add_u32 v5, v3, 3, s64
    v_mov_b32 v3, 1073741824
    v_cmp_lt_u32 vcc, 20, v2
    s_nop 1
    v_cndmask_b32 v5, v5, v3, vcc
    v_cmp_lt_u32 vcc, 31, v1
    s_nop 1
    v_cndmask_b32 v9, v5, v3, vcc
    s_lshl_b32 s62, s60, 15
    s_and_b32 s63, s60, 1
    s_or_b32 s62, s62, s63
    s_lshl_b32 s63, s60, 13
    s_bfe_u32 s69, s60, 0x10002
    s_or_b32 s63, s63, s69
    s_waitcnt lgkmcnt(0)
    s_barrier
    ds_read_b64_tr_b16 v[144:145], v4 offset:0
    ds_read_b64_tr_b16 v[146:147], v4 offset:264
    ds_read_b64_tr_b16 v[148:149], v6 offset:0
    ds_read_b64_tr_b16 v[150:151], v6 offset:264
    ds_read_b64_tr_b16 v[152:153], v6 offset:32
    ds_read_b64_tr_b16 v[154:155], v6 offset:296
    ds_read_b64_tr_b16 v[156:157], v6 offset:64
    ds_read_b64_tr_b16 v[158:159], v6 offset:328
    ds_read_b64_tr_b16 v[160:161], v4 offset:8448
    ds_read_b64_tr_b16 v[162:163], v4 offset:8712
    ds_read_b64_tr_b16 v[164:165], v6 offset:8448
    ds_read_b64_tr_b16 v[166:167], v6 offset:8712
    ds_read_b64_tr_b16 v[168:169], v6 offset:8480
    ds_read_b64_tr_b16 v[170:171], v6 offset:8744
    ds_read_b64_tr_b16 v[172:173], v6 offset:8512
    ds_read_b64_tr_b16 v[174:175], v6 offset:8776
    s_waitcnt lgkmcnt(8)
    v_mfma_f32_16x16x32_bf16 v[208:211], v[148:151], v[144:147], 0
    v_mfma_f32_16x16x32_bf16 v[212:215], v[152:155], v[144:147], 0
    v_mfma_f32_16x16x32_bf16 v[216:219], v[156:159], v[144:147], 0
    ds_read_b64_tr_b16 v[176:177], v4 offset:16896
    ds_read_b64_tr_b16 v[178:179], v4 offset:17160
    ds_read_b64_tr_b16 v[180:181], v6 offset:16896
    ds_read_b64_tr_b16 v[182:183], v6 offset:17160
    ds_read_b64_tr_b16 v[184:185], v6 offset:16928
    ds_read_b64_tr_b16 v[186:187], v6 offset:17192
    ds_read_b64_tr_b16 v[188:189], v6 offset:16960
    ds_read_b64_tr_b16 v[190:191], v6 offset:17224
    s_waitcnt lgkmcnt(8)
    v_mfma_f32_16x16x32_bf16 v[208:211], v[164:167], v[160:163], v[208:211]
    v_mfma_f32_16x16x32_bf16 v[212:215], v[168:171], v[160:163], v[212:215]
    v_mfma_f32_16x16x32_bf16 v[216:219], v[172:175], v[160:163], v[216:219]
    ds_read_b64_tr_b16 v[192:193], v4 offset:25344
    ds_read_b64_tr_b16 v[194:195], v4 offset:25608
    ds_read_b64_tr_b16 v[196:197], v6 offset:25344
    ds_read_b64_tr_b16 v[198:199], v6 offset:25608
    ds_read_b64_tr_b16 v[200:201], v6 offset:25376
    ds_read_b64_tr_b16 v[202:203], v6 offset:25640
    ds_read_b64_tr_b16 v[204:205], v6 offset:25408
    ds_read_b64_tr_b16 v[206:207], v6 offset:25672
    s_waitcnt lgkmcnt(8)
    v_mfma_f32_16x16x32_bf16 v[208:211], v[180:183], v[176:179], v[208:211]
    v_mfma_f32_16x16x32_bf16 v[212:215], v[184:187], v[176:179], v[212:215]
    v_mfma_f32_16x16x32_bf16 v[216:219], v[188:191], v[176:179], v[216:219]
    ds_read_b64_tr_b16 v[16:17], v4 offset:33792
    ds_read_b64_tr_b16 v[18:19], v4 offset:34056
    ds_read_b64_tr_b16 v[20:21], v6 offset:33792
    ds_read_b64_tr_b16 v[22:23], v6 offset:34056
    ds_read_b64_tr_b16 v[24:25], v6 offset:33824
    ds_read_b64_tr_b16 v[26:27], v6 offset:34088
    ds_read_b64_tr_b16 v[28:29], v6 offset:33856
    ds_read_b64_tr_b16 v[30:31], v6 offset:34120
    s_waitcnt lgkmcnt(8)
    v_mfma_f32_16x16x32_bf16 v[208:211], v[196:199], v[192:195], v[208:211]
    v_mfma_f32_16x16x32_bf16 v[212:215], v[200:203], v[192:195], v[212:215]
    v_mfma_f32_16x16x32_bf16 v[216:219], v[204:207], v[192:195], v[216:219]
    ds_read_b64_tr_b16 v[32:33], v4 offset:42240
    ds_read_b64_tr_b16 v[34:35], v4 offset:42504
    ds_read_b64_tr_b16 v[36:37], v6 offset:42240
    ds_read_b64_tr_b16 v[38:39], v6 offset:42504
    ds_read_b64_tr_b16 v[40:41], v6 offset:42272
    ds_read_b64_tr_b16 v[42:43], v6 offset:42536
    ds_read_b64_tr_b16 v[44:45], v6 offset:42304
    ds_read_b64_tr_b16 v[46:47], v6 offset:42568
    s_waitcnt lgkmcnt(8)
    v_mfma_f32_16x16x32_bf16 v[208:211], v[20:23], v[16:19], v[208:211]
    v_mfma_f32_16x16x32_bf16 v[212:215], v[24:27], v[16:19], v[212:215]
    v_mfma_f32_16x16x32_bf16 v[216:219], v[28:31], v[16:19], v[216:219]
    ds_read_b64_tr_b16 v[80:81], v4 offset:50688
    ds_read_b64_tr_b16 v[82:83], v4 offset:50952
    ds_read_b64_tr_b16 v[84:85], v6 offset:50688
    ds_read_b64_tr_b16 v[86:87], v6 offset:50952
    ds_read_b64_tr_b16 v[88:89], v6 offset:50720
    ds_read_b64_tr_b16 v[90:91], v6 offset:50984
    ds_read_b64_tr_b16 v[92:93], v6 offset:50752
    ds_read_b64_tr_b16 v[94:95], v6 offset:51016
    s_waitcnt lgkmcnt(8)
    v_mfma_f32_16x16x32_bf16 v[208:211], v[36:39], v[32:35], v[208:211]
    v_mfma_f32_16x16x32_bf16 v[212:215], v[40:43], v[32:35], v[212:215]
    v_mfma_f32_16x16x32_bf16 v[216:219], v[44:47], v[32:35], v[216:219]
    ds_read_b64_tr_b16 v[96:97], v4 offset:59136
    ds_read_b64_tr_b16 v[98:99], v4 offset:59400
    ds_read_b64_tr_b16 v[100:101], v6 offset:59136
    ds_read_b64_tr_b16 v[102:103], v6 offset:59400
    ds_read_b64_tr_b16 v[104:105], v6 offset:59168
    ds_read_b64_tr_b16 v[106:107], v6 offset:59432
    ds_read_b64_tr_b16 v[108:109], v6 offset:59200
    ds_read_b64_tr_b16 v[110:111], v6 offset:59464
    s_waitcnt lgkmcnt(8)
    v_mfma_f32_16x16x32_bf16 v[208:211], v[84:87], v[80:83], v[208:211]
    v_mfma_f32_16x16x32_bf16 v[212:215], v[88:91], v[80:83], v[212:215]
    v_mfma_f32_16x16x32_bf16 v[216:219], v[92:95], v[80:83], v[216:219]
    s_waitcnt lgkmcnt(0)
    v_mfma_f32_16x16x32_bf16 v[208:211], v[100:103], v[96:99], v[208:211]
    v_mfma_f32_16x16x32_bf16 v[212:215], v[104:107], v[96:99], v[212:215]
    v_mfma_f32_16x16x32_bf16 v[216:219], v[108:111], v[96:99], v[216:219]
    v_mov_b32 v2, 0x10001
    s_nop 4
    v_cvt_pk_bf16_f32 v220, v208, v209
    v_cvt_pk_bf16_f32 v221, v210, v211
    v_cvt_pk_bf16_f32 v222, v212, v213
    v_cvt_pk_bf16_f32 v223, v214, v215
    v_cvt_pk_bf16_f32 v224, v216, v217
    v_cvt_pk_bf16_f32 v225, v218, v219
    v_bfi_b32 v220, v2, s62, v220
    v_bfi_b32 v221, v2, s63, v221
    v_bfi_b32 v222, v2, s62, v222
    v_bfi_b32 v223, v2, s63, v223
    v_bfi_b32 v224, v2, s62, v224
    v_bfi_b32 v225, v2, s63, v225
    buffer_store_dwordx2 v[220:221], v5, s[36:39], 0 offen offset:0 sc1
    buffer_store_dwordx2 v[222:223], v5, s[36:39], 0 offen offset:672 sc1
    buffer_store_dwordx2 v[224:225], v9, s[36:39], 0 offen offset:1344 sc1
    s_barrier
    v_max3_f32 v36, v48, v49, v50
    v_max3_f32 v37, -v48, -v49, -v50
    v_max3_f32 v36, v36, v51, v52
    v_max3_f32 v37, v37, -v51, -v52
    v_max3_f32 v36, v36, v53, v54
    v_max3_f32 v37, v37, -v53, -v54
    v_max3_f32 v36, v36, v55, v56
    v_max3_f32 v37, v37, -v55, -v56
    v_max_f32 v36, v36, v57
    v_max_f32_e64 v37, v37, -v57
    v_max3_f32 v40, v64, v65, v66
    v_max3_f32 v41, -v64, -v65, -v66
    v_max3_f32 v40, v40, v67, v68
    v_max3_f32 v41, v41, -v67, -v68
    v_max3_f32 v40, v40, v69, v70
    v_max3_f32 v41, v41, -v69, -v70
    v_max3_f32 v40, v40, v71, v72
    v_max3_f32 v41, v41, -v71, -v72
    v_max_f32 v40, v40, v73
    v_max_f32_e64 v41, v41, -v73
    v_permlane32_swap_b32 v36, v37
    s_nop 0
    v_permlane32_swap_b32 v40, v41
    v_max_f32 v36, v36, v37
    v_max_f32 v40, v40, v41
    v_mov_b32 v37, v36
    v_mov_b32 v41, v40
    s_nop 0
    v_permlane32_swap_b32 v36, v37
    v_permlane32_swap_b32 v40, v41
    v_pk_mul_f32 v[38:39], v[36:37], s[76:77] neg_lo:[0,1] neg_hi:[0,1]
    v_pk_mul_f32 v[42:43], v[40:41], s[76:77] neg_lo:[0,1] neg_hi:[0,1]
    v_pk_fma_f32 v[16:17], v[48:49], s[76:77], v[38:39] op_sel:[0,0,0] op_sel_hi:[1,1,0]
    v_pk_fma_f32 v[26:27], v[48:49], s[76:77], v[38:39] op_sel:[0,0,1] op_sel_hi:[1,1,1] neg_lo:[0,1,0] neg_hi:[0,1,0]
    v_pk_fma_f32 v[80:81], v[64:65], s[76:77], v[42:43] op_sel:[0,0,0] op_sel_hi:[1,1,0]
    v_pk_fma_f32 v[90:91], v[64:65], s[76:77], v[42:43] op_sel:[0,0,1] op_sel_hi:[1,1,1] neg_lo:[0,1,0] neg_hi:[0,1,0]
    v_pk_fma_f32 v[18:19], v[50:51], s[76:77], v[38:39] op_sel:[0,0,0] op_sel_hi:[1,1,0]
    v_pk_fma_f32 v[28:29], v[50:51], s[76:77], v[38:39] op_sel:[0,0,1] op_sel_hi:[1,1,1] neg_lo:[0,1,0] neg_hi:[0,1,0]
    v_pk_fma_f32 v[82:83], v[66:67], s[76:77], v[42:43] op_sel:[0,0,0] op_sel_hi:[1,1,0]
    v_pk_fma_f32 v[92:93], v[66:67], s[76:77], v[42:43] op_sel:[0,0,1] op_sel_hi:[1,1,1] neg_lo:[0,1,0] neg_hi:[0,1,0]
    v_pk_fma_f32 v[20:21], v[52:53], s[76:77], v[38:39] op_sel:[0,0,0] op_sel_hi:[1,1,0]
    v_pk_fma_f32 v[30:31], v[52:53], s[76:77], v[38:39] op_sel:[0,0,1] op_sel_hi:[1,1,1] neg_lo:[0,1,0] neg_hi:[0,1,0]
    v_pk_fma_f32 v[84:85], v[68:69], s[76:77], v[42:43] op_sel:[0,0,0] op_sel_hi:[1,1,0]
    v_pk_fma_f32 v[94:95], v[68:69], s[76:77], v[42:43] op_sel:[0,0,1] op_sel_hi:[1,1,1] neg_lo:[0,1,0] neg_hi:[0,1,0]
    v_pk_fma_f32 v[22:23], v[54:55], s[76:77], v[38:39] op_sel:[0,0,0] op_sel_hi:[1,1,0]
    v_pk_fma_f32 v[32:33], v[54:55], s[76:77], v[38:39] op_sel:[0,0,1] op_sel_hi:[1,1,1] neg_lo:[0,1,0] neg_hi:[0,1,0]
    v_pk_fma_f32 v[86:87], v[70:71], s[76:77], v[42:43] op_sel:[0,0,0] op_sel_hi:[1,1,0]
    v_pk_fma_f32 v[96:97], v[70:71], s[76:77], v[42:43] op_sel:[0,0,1] op_sel_hi:[1,1,1] neg_lo:[0,1,0] neg_hi:[0,1,0]
    v_pk_fma_f32 v[24:25], v[56:57], s[76:77], v[38:39] op_sel:[0,0,0] op_sel_hi:[1,1,0]
    v_pk_fma_f32 v[34:35], v[56:57], s[76:77], v[38:39] op_sel:[0,0,1] op_sel_hi:[1,1,1] neg_lo:[0,1,0] neg_hi:[0,1,0]
    v_pk_fma_f32 v[88:89], v[72:73], s[76:77], v[42:43] op_sel:[0,0,0] op_sel_hi:[1,1,0]
    v_pk_fma_f32 v[98:99], v[72:73], s[76:77], v[42:43] op_sel:[0,0,1] op_sel_hi:[1,1,1] neg_lo:[0,1,0] neg_hi:[0,1,0]
    v_exp_f32 v16, v16
    v_exp_f32 v80, v80
    v_exp_f32 v17, v17
    v_exp_f32 v81, v81
    v_exp_f32 v18, v18
    v_exp_f32 v82, v82
    v_exp_f32 v19, v19
    v_exp_f32 v83, v83
    v_exp_f32 v20, v20
    v_exp_f32 v84, v84
    v_exp_f32 v21, v21
    v_exp_f32 v85, v85
    v_exp_f32 v22, v22
    v_exp_f32 v86, v86
    v_exp_f32 v23, v23
    v_exp_f32 v87, v87
    v_exp_f32 v24, v24
    v_exp_f32 v88, v88
    v_exp_f32 v25, v25
    v_exp_f32 v89, v89
    v_exp_f32 v26, v26
    v_exp_f32 v90, v90
    v_exp_f32 v27, v27
    v_exp_f32 v91, v91
    v_exp_f32 v28, v28
    v_exp_f32 v92, v92
    v_exp_f32 v29, v29
    v_exp_f32 v93, v93
    v_exp_f32 v30, v30
    v_exp_f32 v94, v94
    v_exp_f32 v31, v31
    v_exp_f32 v95, v95
    v_exp_f32 v32, v32
    v_exp_f32 v96, v96
    v_exp_f32 v33, v33
    v_exp_f32 v97, v97
    v_exp_f32 v34, v34
    v_exp_f32 v98, v98
    v_exp_f32 v35, v35
    v_exp_f32 v99, v99
    v_pk_add_f32 v[36:37], v[16:17], v[18:19]
    v_pk_add_f32 v[38:39], v[26:27], v[28:29]
    v_pk_add_f32 v[40:41], v[80:81], v[82:83]
    v_pk_add_f32 v[42:43], v[90:91], v[92:93]
    v_pk_add_f32 v[36:37], v[36:37], v[20:21]
    v_pk_add_f32 v[38:39], v[38:39], v[30:31]
    v_pk_add_f32 v[40:41], v[40:41], v[84:85]
    v_pk_add_f32 v[42:43], v[42:43], v[94:95]
    v_pk_add_f32 v[36:37], v[36:37], v[22:23]
    v_pk_add_f32 v[38:39], v[38:39], v[32:33]
    v_pk_add_f32 v[40:41], v[40:41], v[86:87]
    v_pk_add_f32 v[42:43], v[42:43], v[96:97]
    v_pk_add_f32 v[36:37], v[36:37], v[24:25]
    v_pk_add_f32 v[38:39], v[38:39], v[34:35]
    v_pk_add_f32 v[40:41], v[40:41], v[88:89]
    v_pk_add_f32 v[42:43], v[42:43], v[98:99]
    v_add_f32 v36, v36, v37
    v_add_f32 v37, v38, v39
    v_add_f32 v40, v40, v41
    v_add_f32 v41, v42, v43
    v_permlane32_swap_b32 v36, v37
    s_nop 0
    v_permlane32_swap_b32 v40, v41
    v_add_f32 v36, v36, v37
    v_add_f32 v40, v40, v41
    v_rcp_f32 v36, v36
    v_rcp_f32 v40, v40
    v_mov_b32 v37, v36
    v_mov_b32 v41, v40
    s_nop 0
    v_permlane32_swap_b32 v36, v37
    v_permlane32_swap_b32 v40, v41
    v_pk_mul_f32 v[16:17], v[16:17], v[36:37] op_sel:[0,0] op_sel_hi:[1,0]
    v_pk_mul_f32 v[26:27], v[26:27], v[36:37] op_sel:[0,1] op_sel_hi:[1,1]
    v_pk_mul_f32 v[80:81], v[80:81], v[40:41] op_sel:[0,0] op_sel_hi:[1,0]
    v_pk_mul_f32 v[90:91], v[90:91], v[40:41] op_sel:[0,1] op_sel_hi:[1,1]
    v_pk_mul_f32 v[18:19], v[18:19], v[36:37] op_sel:[0,0] op_sel_hi:[1,0]
    v_pk_mul_f32 v[28:29], v[28:29], v[36:37] op_sel:[0,1] op_sel_hi:[1,1]
    v_pk_mul_f32 v[82:83], v[82:83], v[40:41] op_sel:[0,0] op_sel_hi:[1,0]
    v_pk_mul_f32 v[92:93], v[92:93], v[40:41] op_sel:[0,1] op_sel_hi:[1,1]
    v_pk_mul_f32 v[20:21], v[20:21], v[36:37] op_sel:[0,0] op_sel_hi:[1,0]
    v_pk_mul_f32 v[30:31], v[30:31], v[36:37] op_sel:[0,1] op_sel_hi:[1,1]
    v_pk_mul_f32 v[84:85], v[84:85], v[40:41] op_sel:[0,0] op_sel_hi:[1,0]
    v_pk_mul_f32 v[94:95], v[94:95], v[40:41] op_sel:[0,1] op_sel_hi:[1,1]
    v_pk_mul_f32 v[22:23], v[22:23], v[36:37] op_sel:[0,0] op_sel_hi:[1,0]
    v_pk_mul_f32 v[32:33], v[32:33], v[36:37] op_sel:[0,1] op_sel_hi:[1,1]
    v_pk_mul_f32 v[86:87], v[86:87], v[40:41] op_sel:[0,0] op_sel_hi:[1,0]
    v_pk_mul_f32 v[96:97], v[96:97], v[40:41] op_sel:[0,1] op_sel_hi:[1,1]
    v_pk_mul_f32 v[24:25], v[24:25], v[36:37] op_sel:[0,0] op_sel_hi:[1,0]
    v_pk_mul_f32 v[34:35], v[34:35], v[36:37] op_sel:[0,1] op_sel_hi:[1,1]
    v_pk_mul_f32 v[88:89], v[88:89], v[40:41] op_sel:[0,0] op_sel_hi:[1,0]
    v_pk_mul_f32 v[98:99], v[98:99], v[40:41] op_sel:[0,1] op_sel_hi:[1,1]
    v_cvt_pk_bf16_f32 v144, v16, v17
    v_cvt_pk_bf16_f32 v156, v80, v81
    v_cvt_pk_bf16_f32 v145, v18, v19
    v_cvt_pk_bf16_f32 v157, v82, v83
    v_cvt_pk_bf16_f32 v146, v20, v21
    v_cvt_pk_bf16_f32 v158, v84, v85
    v_cvt_pk_bf16_f32 v147, v22, v23
    v_cvt_pk_bf16_f32 v159, v86, v87
    v_cvt_pk_bf16_f32 v148, v24, v25
    v_cvt_pk_bf16_f32 v160, v88, v89
    v_cvt_pk_bf16_f32 v149, v26, v27
    v_cvt_pk_bf16_f32 v161, v90, v91
    v_cvt_pk_bf16_f32 v150, v28, v29
    v_cvt_pk_bf16_f32 v162, v92, v93
    v_cvt_pk_bf16_f32 v151, v30, v31
    v_cvt_pk_bf16_f32 v163, v94, v95
    v_cvt_pk_bf16_f32 v152, v32, v33
    v_cvt_pk_bf16_f32 v164, v96, v97
    v_cvt_pk_bf16_f32 v153, v34, v35
    v_cvt_pk_bf16_f32 v165, v98, v99
    v_mov_b32 v154, 0
    v_mov_b32 v155, 0
    v_mov_b32 v166, 0
    v_mov_b32 v167, 0
    v_max3_f32 v36, v112, v113, v114
    v_max3_f32 v37, -v112, -v113, -v114
    v_max3_f32 v36, v36, v115, v116
    v_max3_f32 v37, v37, -v115, -v116
    v_max3_f32 v36, v36, v117, v118
    v_max3_f32 v37, v37, -v117, -v118
    v_max3_f32 v36, v36, v119, v120
    v_max3_f32 v37, v37, -v119, -v120
    v_max_f32 v36, v36, v121
    v_max_f32_e64 v37, v37, -v121
    v_max3_f32 v40, v128, v129, v130
    v_max3_f32 v41, -v128, -v129, -v130
    v_max3_f32 v40, v40, v131, v132
    v_max3_f32 v41, v41, -v131, -v132
    v_max3_f32 v40, v40, v133, v134
    v_max3_f32 v41, v41, -v133, -v134
    v_max3_f32 v40, v40, v135, v136
    v_max3_f32 v41, v41, -v135, -v136
    v_max_f32 v40, v40, v137
    v_max_f32_e64 v41, v41, -v137
    v_permlane32_swap_b32 v36, v37
    s_nop 0
    v_permlane32_swap_b32 v40, v41
    v_max_f32 v36, v36, v37
    v_max_f32 v40, v40, v41
    v_mov_b32 v37, v36
    v_mov_b32 v41, v40
    s_nop 0
    v_permlane32_swap_b32 v36, v37
    v_permlane32_swap_b32 v40, v41
    v_pk_mul_f32 v[38:39], v[36:37], s[76:77] neg_lo:[0,1] neg_hi:[0,1]
    v_pk_mul_f32 v[42:43], v[40:41], s[76:77] neg_lo:[0,1] neg_hi:[0,1]
    v_pk_fma_f32 v[16:17], v[112:113], s[76:77], v[38:39] op_sel:[0,0,0] op_sel_hi:[1,1,0]
    v_pk_fma_f32 v[26:27], v[112:113], s[76:77], v[38:39] op_sel:[0,0,1] op_sel_hi:[1,1,1] neg_lo:[0,1,0] neg_hi:[0,1,0]
    v_pk_fma_f32 v[80:81], v[128:129], s[76:77], v[42:43] op_sel:[0,0,0] op_sel_hi:[1,1,0]
    v_pk_fma_f32 v[90:91], v[128:129], s[76:77], v[42:43] op_sel:[0,0,1] op_sel_hi:[1,1,1] neg_lo:[0,1,0] neg_hi:[0,1,0]
    v_pk_fma_f32 v[18:19], v[114:115], s[76:77], v[38:39] op_sel:[0,0,0] op_sel_hi:[1,1,0]
    v_pk_fma_f32 v[28:29], v[114:115], s[76:77], v[38:39] op_sel:[0,0,1] op_sel_hi:[1,1,1] neg_lo:[0,1,0] neg_hi:[0,1,0]
    v_pk_fma_f32 v[82:83], v[130:131], s[76:77], v[42:43] op_sel:[0,0,0] op_sel_hi:[1,1,0]
    v_pk_fma_f32 v[92:93], v[130:131], s[76:77], v[42:43] op_sel:[0,0,1] op_sel_hi:[1,1,1] neg_lo:[0,1,0] neg_hi:[0,1,0]
    v_pk_fma_f32 v[20:21], v[116:117], s[76:77], v[38:39] op_sel:[0,0,0] op_sel_hi:[1,1,0]
    v_pk_fma_f32 v[30:31], v[116:117], s[76:77], v[38:39] op_sel:[0,0,1] op_sel_hi:[1,1,1] neg_lo:[0,1,0] neg_hi:[0,1,0]
    v_pk_fma_f32 v[84:85], v[132:133], s[76:77], v[42:43] op_sel:[0,0,0] op_sel_hi:[1,1,0]
    v_pk_fma_f32 v[94:95], v[132:133], s[76:77], v[42:43] op_sel:[0,0,1] op_sel_hi:[1,1,1] neg_lo:[0,1,0] neg_hi:[0,1,0]
    v_pk_fma_f32 v[22:23], v[118:119], s[76:77], v[38:39] op_sel:[0,0,0] op_sel_hi:[1,1,0]
    v_pk_fma_f32 v[32:33], v[118:119], s[76:77], v[38:39] op_sel:[0,0,1] op_sel_hi:[1,1,1] neg_lo:[0,1,0] neg_hi:[0,1,0]
    v_pk_fma_f32 v[86:87], v[134:135], s[76:77], v[42:43] op_sel:[0,0,0] op_sel_hi:[1,1,0]
    v_pk_fma_f32 v[96:97], v[134:135], s[76:77], v[42:43] op_sel:[0,0,1] op_sel_hi:[1,1,1] neg_lo:[0,1,0] neg_hi:[0,1,0]
    v_pk_fma_f32 v[24:25], v[120:121], s[76:77], v[38:39] op_sel:[0,0,0] op_sel_hi:[1,1,0]
    v_pk_fma_f32 v[34:35], v[120:121], s[76:77], v[38:39] op_sel:[0,0,1] op_sel_hi:[1,1,1] neg_lo:[0,1,0] neg_hi:[0,1,0]
    v_pk_fma_f32 v[88:89], v[136:137], s[76:77], v[42:43] op_sel:[0,0,0] op_sel_hi:[1,1,0]
    v_pk_fma_f32 v[98:99], v[136:137], s[76:77], v[42:43] op_sel:[0,0,1] op_sel_hi:[1,1,1] neg_lo:[0,1,0] neg_hi:[0,1,0]
    v_exp_f32 v16, v16
    v_exp_f32 v80, v80
    v_exp_f32 v17, v17
    v_exp_f32 v81, v81
    v_exp_f32 v18, v18
    v_exp_f32 v82, v82
    v_exp_f32 v19, v19
    v_exp_f32 v83, v83
    v_exp_f32 v20, v20
    v_exp_f32 v84, v84
    v_exp_f32 v21, v21
    v_exp_f32 v85, v85
    v_exp_f32 v22, v22
    v_exp_f32 v86, v86
    v_exp_f32 v23, v23
    v_exp_f32 v87, v87
    v_exp_f32 v24, v24
    v_exp_f32 v88, v88
    v_exp_f32 v25, v25
    v_exp_f32 v89, v89
    v_exp_f32 v26, v26
    v_exp_f32 v90, v90
    v_exp_f32 v27, v27
    v_exp_f32 v91, v91
    v_exp_f32 v28, v28
    v_exp_f32 v92, v92
    v_exp_f32 v29, v29
    v_exp_f32 v93, v93
    v_exp_f32 v30, v30
    v_exp_f32 v94, v94
    v_exp_f32 v31, v31
    v_exp_f32 v95, v95
    v_exp_f32 v32, v32
    v_exp_f32 v96, v96
    v_exp_f32 v33, v33
    v_exp_f32 v97, v97
    v_exp_f32 v34, v34
    v_exp_f32 v98, v98
    v_exp_f32 v35, v35
    v_exp_f32 v99, v99
    v_pk_add_f32 v[36:37], v[16:17], v[18:19]
    v_pk_add_f32 v[38:39], v[26:27], v[28:29]
    v_pk_add_f32 v[40:41], v[80:81], v[82:83]
    v_pk_add_f32 v[42:43], v[90:91], v[92:93]
    v_pk_add_f32 v[36:37], v[36:37], v[20:21]
    v_pk_add_f32 v[38:39], v[38:39], v[30:31]
    v_pk_add_f32 v[40:41], v[40:41], v[84:85]
    v_pk_add_f32 v[42:43], v[42:43], v[94:95]
    v_pk_add_f32 v[36:37], v[36:37], v[22:23]
    v_pk_add_f32 v[38:39], v[38:39], v[32:33]
    v_pk_add_f32 v[40:41], v[40:41], v[86:87]
    v_pk_add_f32 v[42:43], v[42:43], v[96:97]
    v_pk_add_f32 v[36:37], v[36:37], v[24:25]
    v_pk_add_f32 v[38:39], v[38:39], v[34:35]
    v_pk_add_f32 v[40:41], v[40:41], v[88:89]
    v_pk_add_f32 v[42:43], v[42:43], v[98:99]
    v_add_f32 v36, v36, v37
    v_add_f32 v37, v38, v39
    v_add_f32 v40, v40, v41
    v_add_f32 v41, v42, v43
    v_permlane32_swap_b32 v36, v37
    s_nop 0
    v_permlane32_swap_b32 v40, v41
    v_add_f32 v36, v36, v37
    v_add_f32 v40, v40, v41
    v_rcp_f32 v36, v36
    v_rcp_f32 v40, v40
    v_mov_b32 v37, v36
    v_mov_b32 v41, v40
    s_nop 0
    v_permlane32_swap_b32 v36, v37
    v_permlane32_swap_b32 v40, v41
    v_pk_mul_f32 v[16:17], v[16:17], v[36:37] op_sel:[0,0] op_sel_hi:[1,0]
    v_pk_mul_f32 v[26:27], v[26:27], v[36:37] op_sel:[0,1] op_sel_hi:[1,1]
    v_pk_mul_f32 v[80:81], v[80:81], v[40:41] op_sel:[0,0] op_sel_hi:[1,0]
    v_pk_mul_f32 v[90:91], v[90:91], v[40:41] op_sel:[0,1] op_sel_hi:[1,1]
    v_pk_mul_f32 v[18:19], v[18:19], v[36:37] op_sel:[0,0] op_sel_hi:[1,0]
    v_pk_mul_f32 v[28:29], v[28:29], v[36:37] op_sel:[0,1] op_sel_hi:[1,1]
    v_pk_mul_f32 v[82:83], v[82:83], v[40:41] op_sel:[0,0] op_sel_hi:[1,0]
    v_pk_mul_f32 v[92:93], v[92:93], v[40:41] op_sel:[0,1] op_sel_hi:[1,1]
    v_pk_mul_f32 v[20:21], v[20:21], v[36:37] op_sel:[0,0] op_sel_hi:[1,0]
    v_pk_mul_f32 v[30:31], v[30:31], v[36:37] op_sel:[0,1] op_sel_hi:[1,1]
    v_pk_mul_f32 v[84:85], v[84:85], v[40:41] op_sel:[0,0] op_sel_hi:[1,0]
    v_pk_mul_f32 v[94:95], v[94:95], v[40:41] op_sel:[0,1] op_sel_hi:[1,1]
    v_pk_mul_f32 v[22:23], v[22:23], v[36:37] op_sel:[0,0] op_sel_hi:[1,0]
    v_pk_mul_f32 v[32:33], v[32:33], v[36:37] op_sel:[0,1] op_sel_hi:[1,1]
    v_pk_mul_f32 v[86:87], v[86:87], v[40:41] op_sel:[0,0] op_sel_hi:[1,0]
    v_pk_mul_f32 v[96:97], v[96:97], v[40:41] op_sel:[0,1] op_sel_hi:[1,1]
    v_pk_mul_f32 v[24:25], v[24:25], v[36:37] op_sel:[0,0] op_sel_hi:[1,0]
    v_pk_mul_f32 v[34:35], v[34:35], v[36:37] op_sel:[0,1] op_sel_hi:[1,1]
    v_pk_mul_f32 v[88:89], v[88:89], v[40:41] op_sel:[0,0] op_sel_hi:[1,0]
    v_pk_mul_f32 v[98:99], v[98:99], v[40:41] op_sel:[0,1] op_sel_hi:[1,1]
    v_cvt_pk_bf16_f32 v168, v16, v17
    v_cvt_pk_bf16_f32 v180, v80, v81
    v_cvt_pk_bf16_f32 v169, v18, v19
    v_cvt_pk_bf16_f32 v181, v82, v83
    v_cvt_pk_bf16_f32 v170, v20, v21
    v_cvt_pk_bf16_f32 v182, v84, v85
    v_cvt_pk_bf16_f32 v171, v22, v23
    v_cvt_pk_bf16_f32 v183, v86, v87
    v_cvt_pk_bf16_f32 v172, v24, v25
    v_cvt_pk_bf16_f32 v184, v88, v89
    v_cvt_pk_bf16_f32 v173, v26, v27
    v_cvt_pk_bf16_f32 v185, v90, v91
    v_cvt_pk_bf16_f32 v174, v28, v29
    v_cvt_pk_bf16_f32 v186, v92, v93
    v_cvt_pk_bf16_f32 v175, v30, v31
    v_cvt_pk_bf16_f32 v187, v94, v95
    v_cvt_pk_bf16_f32 v176, v32, v33
    v_cvt_pk_bf16_f32 v188, v96, v97
    v_cvt_pk_bf16_f32 v177, v34, v35
    v_cvt_pk_bf16_f32 v189, v98, v99
    v_mov_b32 v178, 0
    v_mov_b32 v179, 0
    v_mov_b32 v190, 0
    v_mov_b32 v191, 0
    s_mov_b32 s40, s30
    s_and_b32 s41, s31, 0xffff
    s_mov_b32 s42, 10485760
    s_mov_b32 s43, 0x00020000
    s_lshl_b32 s62, s75, 2
    s_add_u32 s62, s62, s58
    s_lshl_b32 s64, s62, 5
    v_lshl_add_u32 v2, v13, 2, s64
    s_mul_i32 s65, s81, 96
    v_add_lshl_u32 v3, v12, s65, 2
    v_mul_u32_u24 v5, 5120, v2
    v_add_u32 v5, v5, v3
    s_cmp_eq_u32 s81, 6
    s_cselect_b32 s65, 1073741824, 0
    v_add_u32 v8, s65, v5
    s_mul_i32 s66, s62, 40960
    s_add_u32 s66, s66, 14680064
    v_lshl_add_u32 v4, v1, 4, s66
    v_bfe_u32 v3, v1, 2, 2
    v_mul_u32_u24 v6, 320, v3
    v_lshl_add_u32 v6, v13, 11, v6
    v_bfe_u32 v3, v1, 4, 1
    v_lshl_add_u32 v6, v3, 5, v6
    v_and_b32 v3, 3, v1
    v_lshl_add_u32 v6, v3, 3, v6
    s_and_b32 s63, s75, 1
    s_lshl_b32 s63, s63, 1
    s_lshr_b32 s64, s58, 1
    s_add_u32 s63, s63, s64
    s_lshl_b32 s63, s63, 6
    s_lshr_b32 s64, s75, 1
    s_lshl_b32 s62, s64, 8
    s_add_u32 s62, s62, 20480
    s_add_u32 s62, s62, s63
    v_and_b32 v10, 15, v1
    v_lshl_add_u32 v10, v10, 2, s62
    s_mul_i32 s67, s58, 16
    s_add_u32 s67, s67, s82
    s_lshl_b32 s67, s67, 2
    s_lshl_b32 s69, s56, 8
    s_add_u32 s67, s67, s69
    s_add_u32 s67, s67, 20480
    v_mul_u32_u24 v2, 112, v12
    v_mul_u32_u24 v3, 48, v13
    v_add_u32 v7, v2, v3
    s_lshl_b32 s63, s56, 3
    s_lshl_b32 s64, s58, 1
    s_add_u32 s63, s63, s64
    s_mul_i32 s64, s63, 40960
    s_lshr_b32 s65, s82, 1
    s_mul_i32 s65, s65, 5120
    s_add_u32 s64, s64, s65
    s_add_u32 s64, s64, 14680064
    v_lshl_add_u32 v9, v1, 4, s64
    s_and_b32 s65, s82, 1
    s_lshl_b32 s66, s65, 11
    s_lshl_b32 s65, s65, 3
    s_add_u32 s65, s65, 4096
    s_add_u32 s63, s66, 40960
    s_add_u32 s64, s65, 40960
    s_barrier
    ds_read_b128 v[48:51], v7 offset:5632
    ds_read_b128 v[52:55], v7 offset:5648
    ds_read_b128 v[56:59], v7 offset:5664
    ds_read_b128 v[60:63], v7 offset:9216
    ds_read_b128 v[64:67], v7 offset:9232
    ds_read_b128 v[68:71], v7 offset:9248
    s_waitcnt lgkmcnt(0)
    v_mfma_f32_32x32x16_bf16 v[16:31], v[48:51], v[144:147], 0
    v_mfma_f32_32x32x16_bf16 v[32:47], v[60:63], v[156:159], 0
    v_mfma_f32_32x32x16_bf16 v[16:31], v[52:55], v[148:151], v[16:31]
    v_mfma_f32_32x32x16_bf16 v[32:47], v[64:67], v[160:163], v[32:47]
    v_mfma_f32_32x32x16_bf16 v[16:31], v[56:59], v[152:155], v[16:31]
    v_mfma_f32_32x32x16_bf16 v[32:47], v[68:71], v[164:167], v[32:47]
    v_mfma_f32_32x32x16_bf16 v[80:95], v[48:51], v[168:171], 0
    v_mfma_f32_32x32x16_bf16 v[96:111], v[60:63], v[180:183], 0
    v_mfma_f32_32x32x16_bf16 v[80:95], v[52:55], v[172:175], v[80:95]
    v_mfma_f32_32x32x16_bf16 v[96:111], v[64:67], v[184:187], v[96:111]
    v_mfma_f32_32x32x16_bf16 v[80:95], v[56:59], v[176:179], v[80:95]
    v_mfma_f32_32x32x16_bf16 v[96:111], v[68:71], v[188:191], v[96:111]
    s_nop 4
    v_add_f32 v26, 0x358637bd, v26
    v_add_f32 v42, 0x358637bd, v42
    v_rcp_f32 v26, v26
    v_rcp_f32 v42, v42
    v_pk_mul_f32 v[16:17], v[16:17], v[26:27] op_sel:[0,0] op_sel_hi:[1,0]
    v_pk_mul_f32 v[32:33], v[32:33], v[42:43] op_sel:[0,0] op_sel_hi:[1,0]
    v_pk_mul_f32 v[18:19], v[18:19], v[26:27] op_sel:[0,0] op_sel_hi:[1,0]
    v_pk_mul_f32 v[34:35], v[34:35], v[42:43] op_sel:[0,0] op_sel_hi:[1,0]
    v_pk_mul_f32 v[20:21], v[20:21], v[26:27] op_sel:[0,0] op_sel_hi:[1,0]
    v_pk_mul_f32 v[36:37], v[36:37], v[42:43] op_sel:[0,0] op_sel_hi:[1,0]
    v_pk_mul_f32 v[22:23], v[22:23], v[26:27] op_sel:[0,0] op_sel_hi:[1,0]
    v_pk_mul_f32 v[38:39], v[38:39], v[42:43] op_sel:[0,0] op_sel_hi:[1,0]
    v_pk_mul_f32 v[24:25], v[24:25], v[26:27] op_sel:[0,0] op_sel_hi:[1,0]
    v_pk_mul_f32 v[40:41], v[40:41], v[42:43] op_sel:[0,0] op_sel_hi:[1,0]
    v_cvt_pk_bf16_f32 v192, v16, v17
    v_cvt_pk_bf16_f32 v193, v18, v19
    v_cvt_pk_bf16_f32 v194, v20, v21
    v_cvt_pk_bf16_f32 v195, v22, v23
    v_cvt_pk_bf16_f32 v196, v24, v25
    v_cvt_pk_bf16_f32 v197, v32, v33
    v_cvt_pk_bf16_f32 v198, v34, v35
    v_cvt_pk_bf16_f32 v199, v36, v37
    v_cvt_pk_bf16_f32 v200, v38, v39
    v_cvt_pk_bf16_f32 v201, v40, v41
    buffer_store_dwordx4 v[192:195], v9, s[36:39], s66 offen sc1
    buffer_store_dwordx4 v[196:199], v9, s[36:39], s66 offen offset:1024 sc1
    buffer_store_dwordx2 v[200:201], v9, s[36:39], s65 offen sc1
    v_add_f32 v90, 0x358637bd, v90
    v_add_f32 v106, 0x358637bd, v106
    v_rcp_f32 v90, v90
    v_rcp_f32 v106, v106
    v_pk_mul_f32 v[80:81], v[80:81], v[90:91] op_sel:[0,0] op_sel_hi:[1,0]
    v_pk_mul_f32 v[96:97], v[96:97], v[106:107] op_sel:[0,0] op_sel_hi:[1,0]
    v_pk_mul_f32 v[82:83], v[82:83], v[90:91] op_sel:[0,0] op_sel_hi:[1,0]
    v_pk_mul_f32 v[98:99], v[98:99], v[106:107] op_sel:[0,0] op_sel_hi:[1,0]
    v_pk_mul_f32 v[84:85], v[84:85], v[90:91] op_sel:[0,0] op_sel_hi:[1,0]
    v_pk_mul_f32 v[100:101], v[100:101], v[106:107] op_sel:[0,0] op_sel_hi:[1,0]
    v_pk_mul_f32 v[86:87], v[86:87], v[90:91] op_sel:[0,0] op_sel_hi:[1,0]
    v_pk_mul_f32 v[102:103], v[102:103], v[106:107] op_sel:[0,0] op_sel_hi:[1,0]
    v_pk_mul_f32 v[88:89], v[88:89], v[90:91] op_sel:[0,0] op_sel_hi:[1,0]
    v_pk_mul_f32 v[104:105], v[104:105], v[106:107] op_sel:[0,0] op_sel_hi:[1,0]
    v_cvt_pk_bf16_f32 v204, v80, v81
    v_cvt_pk_bf16_f32 v205, v82, v83
    v_cvt_pk_bf16_f32 v206, v84, v85
    v_cvt_pk_bf16_f32 v207, v86, v87
    v_cvt_pk_bf16_f32 v208, v88, v89
    v_cvt_pk_bf16_f32 v209, v96, v97
    v_cvt_pk_bf16_f32 v210, v98, v99
    v_cvt_pk_bf16_f32 v211, v100, v101
    v_cvt_pk_bf16_f32 v212, v102, v103
    v_cvt_pk_bf16_f32 v213, v104, v105
    buffer_store_dwordx4 v[204:207], v9, s[36:39], s63 offen sc1
    buffer_store_dwordx4 v[208:211], v9, s[36:39], s63 offen offset:1024 sc1
    buffer_store_dwordx2 v[212:213], v9, s[36:39], s64 offen sc1
    v_mov_b32 v16, 0
    v_mov_b32 v17, 0
    v_mov_b32 v18, 0
    v_mov_b32 v19, 0
    v_mov_b32 v20, 0
    v_mov_b32 v21, 0
    v_mov_b32 v22, 0
    v_mov_b32 v23, 0
    v_mov_b32 v24, 0
    v_mov_b32 v25, 0
    v_mov_b32 v26, 0
    v_mov_b32 v27, 0
    v_mov_b32 v28, 0
    v_mov_b32 v29, 0
    v_mov_b32 v30, 0
    v_mov_b32 v31, 0
    v_mov_b32 v32, 0
    v_mov_b32 v33, 0
    v_mov_b32 v34, 0
    v_mov_b32 v35, 0
    v_mov_b32 v36, 0
    v_mov_b32 v37, 0
    v_mov_b32 v38, 0
    v_mov_b32 v39, 0
    v_mov_b32 v40, 0
    v_mov_b32 v41, 0
    v_mov_b32 v42, 0
    v_mov_b32 v43, 0
    v_mov_b32 v44, 0
    v_mov_b32 v45, 0
    v_mov_b32 v46, 0
    v_mov_b32 v47, 0
    v_mov_b32 v48, 0
    v_mov_b32 v49, 0
    v_mov_b32 v50, 0
    v_mov_b32 v51, 0
    v_mov_b32 v52, 0
    v_mov_b32 v53, 0
    v_mov_b32 v54, 0
    v_mov_b32 v55, 0
    v_mov_b32 v56, 0
    v_mov_b32 v57, 0
    v_mov_b32 v58, 0
    v_mov_b32 v59, 0
    v_mov_b32 v60, 0
    v_mov_b32 v61, 0
    v_mov_b32 v62, 0
    v_mov_b32 v63, 0
    s_waitcnt vmcnt(0)
    v_mov_b32 v2, 0
    v_mov_b32 v3, s60
    s_mov_b64 exec, 1
    buffer_store_dword v3, v2, s[36:39], s67 offen sc1
    s_mov_b64 exec, -1
    s_barrier
    s_cmp_eq_u32 s81, 7
    s_cbranch_scc1 L_end
    buffer_load_dword v13, v10, s[36:39], 0 offen sc1
    s_mov_b32 s69, 0
Lpoll_1:
    s_waitcnt vmcnt(0)
    v_cmp_eq_u32 vcc, s60, v13
    s_cmp_eq_u64 vcc, -1
    s_cbranch_scc1 Lpollok_2
    s_sleep 1
    buffer_load_dword v13, v10, s[36:39], 0 offen sc1
    s_add_u32 s69, s69, 1
    s_cmp_lt_u32 s69, 0x40000
    s_cbranch_scc1 Lpoll_1
    s_waitcnt vmcnt(0)
Lpollok_2:
    s_mul_i32 s70, s83, 5120
    v_xor_b32 v7, 0, v6
    v_xor_b32 v9, 64, v6
    v_xor_b32 v11, 128, v6
    s_add_u32 s71, s70, 4096
    buffer_load_dwordx4 v[120:123], v4, s[36:39], s70 offen offset:0 sc1
    buffer_load_dwordx4 v[124:127], v4, s[36:39], s70 offen offset:1024 sc1
    buffer_load_dwordx4 v[128:131], v4, s[36:39], s70 offen offset:2048 sc1
    buffer_load_dwordx4 v[132:135], v4, s[36:39], s70 offen offset:3072 sc1
    buffer_load_dwordx4 v[136:139], v4, s[36:39], s71 offen offset:0 sc1
    s_add_u32 s70, s70, 5120
    s_cmp_ge_u32 s70, 40960
    s_cselect_b32 s70, 0, s70
    s_add_u32 s71, s70, 4096
    buffer_load_dwordx4 v[140:143], v4, s[36:39], s70 offen offset:0 sc1
    buffer_load_dwordx4 v[144:147], v4, s[36:39], s70 offen offset:1024 sc1
    buffer_load_dwordx4 v[148:151], v4, s[36:39], s70 offen offset:2048 sc1
    buffer_load_dwordx4 v[152:155], v4, s[36:39], s70 offen offset:3072 sc1
    buffer_load_dwordx4 v[156:159], v4, s[36:39], s71 offen offset:0 sc1
    s_add_u32 s70, s70, 5120
    s_cmp_ge_u32 s70, 40960
    s_cselect_b32 s70, 0, s70
    s_add_u32 s71, s70, 4096
    buffer_load_dwordx4 v[160:163], v4, s[36:39], s70 offen offset:0 sc1
    buffer_load_dwordx4 v[164:167], v4, s[36:39], s70 offen offset:1024 sc1
    buffer_load_dwordx4 v[168:171], v4, s[36:39], s70 offen offset:2048 sc1
    buffer_load_dwordx4 v[172:175], v4, s[36:39], s70 offen offset:3072 sc1
    buffer_load_dwordx4 v[176:179], v4, s[36:39], s71 offen offset:0 sc1
    s_add_u32 s70, s70, 5120
    s_cmp_ge_u32 s70, 40960
    s_cselect_b32 s70, 0, s70
    s_add_u32 s71, s70, 4096
    buffer_load_dwordx4 v[180:183], v4, s[36:39], s70 offen offset:0 sc1
    buffer_load_dwordx4 v[184:187], v4, s[36:39], s70 offen offset:1024 sc1
    buffer_load_dwordx4 v[188:191], v4, s[36:39], s70 offen offset:2048 sc1
    buffer_load_dwordx4 v[192:195], v4, s[36:39], s70 offen offset:3072 sc1
    buffer_load_dwordx4 v[196:199], v4, s[36:39], s71 offen offset:0 sc1
    s_add_u32 s70, s70, 5120
    s_cmp_ge_u32 s70, 40960
    s_cselect_b32 s70, 0, s70
    s_add_u32 s71, s70, 4096
    buffer_load_dwordx4 v[200:203], v4, s[36:39], s70 offen offset:0 sc1
    buffer_load_dwordx4 v[204:207], v4, s[36:39], s70 offen offset:1024 sc1
    buffer_load_dwordx4 v[208:211], v4, s[36:39], s70 offen offset:2048 sc1
    buffer_load_dwordx4 v[212:215], v4, s[36:39], s70 offen offset:3072 sc1
    buffer_load_dwordx4 v[216:219], v4, s[36:39], s71 offen offset:0 sc1
    s_add_u32 s70, s70, 5120
    s_cmp_ge_u32 s70, 40960
    s_cselect_b32 s70, 0, s70
    s_add_u32 s71, s70, 4096
    buffer_load_dwordx4 v[220:223], v4, s[36:39], s70 offen offset:0 sc1
    buffer_load_dwordx4 v[224:227], v4, s[36:39], s70 offen offset:1024 sc1
    buffer_load_dwordx4 v[228:231], v4, s[36:39], s70 offen offset:2048 sc1
    buffer_load_dwordx4 v[232:235], v4, s[36:39], s70 offen offset:3072 sc1
    buffer_load_dwordx4 v[236:239], v4, s[36:39], s71 offen offset:0 sc1
    s_add_u32 s70, s70, 5120
    s_cmp_ge_u32 s70, 40960
    s_cselect_b32 s70, 0, s70
    s_add_u32 s71, s70, 4096
    buffer_load_dwordx4 v[240:243], v4, s[36:39], s70 offen offset:0 sc1
    buffer_load_dwordx4 v[244:247], v4, s[36:39], s70 offen offset:1024 sc1
    v_add_u32 v2, 16384, v7
    ds_read_b64_tr_b16 v[64:65], v2 offset:0
    ds_read_b64_tr_b16 v[66:67], v2 offset:1024
    v_add_u32 v2, 20480, v7
    ds_read_b64_tr_b16 v[76:77], v2 offset:0
    ds_read_b64_tr_b16 v[78:79], v2 offset:1024
    v_add_u32 v3, 16384, v9
    ds_read_b64_tr_b16 v[68:69], v3 offset:0
    ds_read_b64_tr_b16 v[70:71], v3 offset:1024
    v_add_u32 v3, 20480, v9
    ds_read_b64_tr_b16 v[80:81], v3 offset:0
    ds_read_b64_tr_b16 v[82:83], v3 offset:1024
    v_add_u32 v12, 16384, v11
    ds_read_b64_tr_b16 v[72:73], v12 offset:0
    ds_read_b64_tr_b16 v[74:75], v12 offset:1024
    v_add_u32 v12, 20480, v11
    ds_read_b64_tr_b16 v[84:85], v12 offset:0
    ds_read_b64_tr_b16 v[86:87], v12 offset:1024
    s_waitcnt vmcnt(31) lgkmcnt(10)
    v_mfma_f32_32x32x16_bf16 v[16:31], v[120:123], v[64:67], v[16:31]
    v_add_u32 v2, 24576, v7
    ds_read_b64_tr_b16 v[88:89], v2 offset:0
    ds_read_b64_tr_b16 v[90:91], v2 offset:1024
    s_waitcnt vmcnt(30) lgkmcnt(10)
    v_mfma_f32_32x32x16_bf16 v[16:31], v[124:127], v[76:79], v[16:31]
    v_add_u32 v2, 28672, v7
    ds_read_b64_tr_b16 v[64:65], v2 offset:0
    ds_read_b64_tr_b16 v[66:67], v2 offset:1024
    s_waitcnt vmcnt(29) lgkmcnt(2)
    v_mfma_f32_32x32x16_bf16 v[16:31], v[128:131], v[88:91], v[16:31]
    v_add_u32 v2, 32768, v7
    ds_read_b64_tr_b16 v[76:77], v2 offset:0
    ds_read_b64_tr_b16 v[78:79], v2 offset:1024
    s_waitcnt vmcnt(28) lgkmcnt(2)
    v_mfma_f32_32x32x16_bf16 v[16:31], v[132:135], v[64:67], v[16:31]
    v_add_u32 v2, 36864, v7
    ds_read_b64_tr_b16 v[88:89], v2 offset:0
    ds_read_b64_tr_b16 v[90:91], v2 offset:1024
    s_waitcnt vmcnt(27) lgkmcnt(2)
    v_mfma_f32_32x32x16_bf16 v[16:31], v[136:139], v[76:79], v[16:31]
    v_add_u32 v2, 40960, v7
    ds_read_b64_tr_b16 v[64:65], v2 offset:0
    ds_read_b64_tr_b16 v[66:67], v2 offset:1024
    v_mfma_f32_32x32x16_bf16 v[32:47], v[120:123], v[68:71], v[32:47]
    v_add_u32 v3, 24576, v9
    ds_read_b64_tr_b16 v[92:93], v3 offset:0
    ds_read_b64_tr_b16 v[94:95], v3 offset:1024
    s_waitcnt vmcnt(26) lgkmcnt(4)
    v_mfma_f32_32x32x16_bf16 v[16:31], v[140:143], v[88:91], v[16:31]
    v_add_u32 v2, 45056, v7
    ds_read_b64_tr_b16 v[76:77], v2 offset:0
    ds_read_b64_tr_b16 v[78:79], v2 offset:1024
    v_mfma_f32_32x32x16_bf16 v[32:47], v[124:127], v[80:83], v[32:47]
    v_add_u32 v3, 28672, v9
    ds_read_b64_tr_b16 v[68:69], v3 offset:0
    ds_read_b64_tr_b16 v[70:71], v3 offset:1024
    s_waitcnt vmcnt(25) lgkmcnt(6)
    v_mfma_f32_32x32x16_bf16 v[16:31], v[144:147], v[64:67], v[16:31]
    v_add_u32 v2, 49152, v7
    ds_read_b64_tr_b16 v[88:89], v2 offset:0
    ds_read_b64_tr_b16 v[90:91], v2 offset:1024
    s_waitcnt lgkmcnt(6)
    v_mfma_f32_32x32x16_bf16 v[32:47], v[128:131], v[92:95], v[32:47]
    v_add_u32 v3, 32768, v9
    ds_read_b64_tr_b16 v[80:81], v3 offset:0
    ds_read_b64_tr_b16 v[82:83], v3 offset:1024
    s_waitcnt vmcnt(24) lgkmcnt(6)
    v_mfma_f32_32x32x16_bf16 v[16:31], v[148:151], v[76:79], v[16:31]
    v_add_u32 v2, 53248, v7
    ds_read_b64_tr_b16 v[64:65], v2 offset:0
    ds_read_b64_tr_b16 v[66:67], v2 offset:1024
    s_waitcnt lgkmcnt(6)
    v_mfma_f32_32x32x16_bf16 v[32:47], v[132:135], v[68:71], v[32:47]
    v_add_u32 v3, 36864, v9
    ds_read_b64_tr_b16 v[92:93], v3 offset:0
    ds_read_b64_tr_b16 v[94:95], v3 offset:1024
    s_waitcnt vmcnt(23) lgkmcnt(6)
    v_mfma_f32_32x32x16_bf16 v[16:31], v[152:155], v[88:91], v[16:31]
    v_add_u32 v2, 57344, v7
    ds_read_b64_tr_b16 v[76:77], v2 offset:0
    ds_read_b64_tr_b16 v[78:79], v2 offset:1024
    s_waitcnt lgkmcnt(6)
    v_mfma_f32_32x32x16_bf16 v[32:47], v[136:139], v[80:83], v[32:47]
    v_add_u32 v3, 40960, v9
    ds_read_b64_tr_b16 v[68:69], v3 offset:0
    ds_read_b64_tr_b16 v[70:71], v3 offset:1024
    v_mfma_f32_32x32x16_bf16 v[48:63], v[120:123], v[72:75], v[48:63]
    v_add_u32 v12, 24576, v11
    ds_read_b64_tr_b16 v[96:97], v12 offset:0
    ds_read_b64_tr_b16 v[98:99], v12 offset:1024
    buffer_load_dwordx4 v[120:123], v4, s[36:39], s70 offen offset:2048 sc1
    s_waitcnt vmcnt(23) lgkmcnt(8)
    v_mfma_f32_32x32x16_bf16 v[16:31], v[156:159], v[64:67], v[16:31]
    v_add_u32 v2, 61440, v7
    ds_read_b64_tr_b16 v[88:89], v2 offset:0
    ds_read_b64_tr_b16 v[90:91], v2 offset:1024
    s_waitcnt lgkmcnt(8)
    v_mfma_f32_32x32x16_bf16 v[32:47], v[140:143], v[92:95], v[32:47]
    v_add_u32 v3, 45056, v9
    ds_read_b64_tr_b16 v[80:81], v3 offset:0
    ds_read_b64_tr_b16 v[82:83], v3 offset:1024
    v_mfma_f32_32x32x16_bf16 v[48:63], v[124:127], v[84:87], v[48:63]
    v_add_u32 v12, 28672, v11
    ds_read_b64_tr_b16 v[72:73], v12 offset:0
    ds_read_b64_tr_b16 v[74:75], v12 offset:1024
    buffer_load_dwordx4 v[124:127], v4, s[36:39], s70 offen offset:3072 sc1
    s_waitcnt vmcnt(23) lgkmcnt(10)
    v_mfma_f32_32x32x16_bf16 v[16:31], v[160:163], v[76:79], v[16:31]
    v_add_u32 v2, 65536, v7
    ds_read_b64_tr_b16 v[64:65], v2 offset:0
    ds_read_b64_tr_b16 v[66:67], v2 offset:1024
    s_waitcnt lgkmcnt(10)
    v_mfma_f32_32x32x16_bf16 v[32:47], v[144:147], v[68:71], v[32:47]
    v_add_u32 v3, 49152, v9
    ds_read_b64_tr_b16 v[92:93], v3 offset:0
    ds_read_b64_tr_b16 v[94:95], v3 offset:1024
    s_waitcnt lgkmcnt(10)
    v_mfma_f32_32x32x16_bf16 v[48:63], v[128:131], v[96:99], v[48:63]
    v_add_u32 v12, 32768, v11
    ds_read_b64_tr_b16 v[84:85], v12 offset:0
    ds_read_b64_tr_b16 v[86:87], v12 offset:1024
    buffer_load_dwordx4 v[128:131], v4, s[36:39], s71 offen offset:0 sc1
    s_add_u32 s70, s70, 5120
    s_cmp_ge_u32 s70, 40960
    s_cselect_b32 s70, 0, s70
    s_waitcnt vmcnt(23) lgkmcnt(10)
    v_mfma_f32_32x32x16_bf16 v[16:31], v[164:167], v[88:91], v[16:31]
    v_add_u32 v2, 69632, v7
    ds_read_b64_tr_b16 v[76:77], v2 offset:0
    ds_read_b64_tr_b16 v[78:79], v2 offset:1024
    s_waitcnt lgkmcnt(10)
    v_mfma_f32_32x32x16_bf16 v[32:47], v[148:151], v[80:83], v[32:47]
    v_add_u32 v3, 53248, v9
    ds_read_b64_tr_b16 v[68:69], v3 offset:0
    ds_read_b64_tr_b16 v[70:71], v3 offset:1024
    s_waitcnt lgkmcnt(10)
    v_mfma_f32_32x32x16_bf16 v[48:63], v[132:135], v[72:75], v[48:63]
    v_add_u32 v12, 36864, v11
    ds_read_b64_tr_b16 v[96:97], v12 offset:0
    ds_read_b64_tr_b16 v[98:99], v12 offset:1024
    s_add_u32 s71, s70, 4096
    buffer_load_dwordx4 v[132:135], v4, s[36:39], s70 offen offset:0 sc1
    s_waitcnt vmcnt(23) lgkmcnt(10)
    v_mfma_f32_32x32x16_bf16 v[16:31], v[168:171], v[64:67], v[16:31]
    v_add_u32 v2, 73728, v7
    ds_read_b64_tr_b16 v[88:89], v2 offset:0
    ds_read_b64_tr_b16 v[90:91], v2 offset:1024
    s_waitcnt lgkmcnt(10)
    v_mfma_f32_32x32x16_bf16 v[32:47], v[152:155], v[92:95], v[32:47]
    v_add_u32 v3, 57344, v9
    ds_read_b64_tr_b16 v[80:81], v3 offset:0
    ds_read_b64_tr_b16 v[82:83], v3 offset:1024
    s_waitcnt lgkmcnt(10)
    v_mfma_f32_32x32x16_bf16 v[48:63], v[136:139], v[84:87], v[48:63]
    v_add_u32 v12, 40960, v11
    ds_read_b64_tr_b16 v[72:73], v12 offset:0
    ds_read_b64_tr_b16 v[74:75], v12 offset:1024
    buffer_load_dwordx4 v[136:139], v4, s[36:39], s70 offen offset:1024 sc1
    s_waitcnt vmcnt(23) lgkmcnt(10)
    v_mfma_f32_32x32x16_bf16 v[16:31], v[172:175], v[76:79], v[16:31]
    v_add_u32 v2, 77824, v7
    ds_read_b64_tr_b16 v[64:65], v2 offset:0
    ds_read_b64_tr_b16 v[66:67], v2 offset:1024
    s_waitcnt lgkmcnt(10)
    v_mfma_f32_32x32x16_bf16 v[32:47], v[156:159], v[68:71], v[32:47]
    v_add_u32 v3, 61440, v9
    ds_read_b64_tr_b16 v[92:93], v3 offset:0
    ds_read_b64_tr_b16 v[94:95], v3 offset:1024
    s_waitcnt lgkmcnt(10)
    v_mfma_f32_32x32x16_bf16 v[48:63], v[140:143], v[96:99], v[48:63]
    v_add_u32 v12, 45056, v11
    ds_read_b64_tr_b16 v[84:85], v12 offset:0
    ds_read_b64_tr_b16 v[86:87], v12 offset:1024
    buffer_load_dwordx4 v[140:143], v4, s[36:39], s70 offen offset:2048 sc1
    s_waitcnt vmcnt(23) lgkmcnt(10)
    v_mfma_f32_32x32x16_bf16 v[16:31], v[176:179], v[88:91], v[16:31]
    v_add_u32 v2, 81920, v7
    ds_read_b64_tr_b16 v[76:77], v2 offset:0
    ds_read_b64_tr_b16 v[78:79], v2 offset:1024
    s_waitcnt lgkmcnt(10)
    v_mfma_f32_32x32x16_bf16 v[32:47], v[160:163], v[80:83], v[32:47]
    v_add_u32 v3, 65536, v9
    ds_read_b64_tr_b16 v[68:69], v3 offset:0
    ds_read_b64_tr_b16 v[70:71], v3 offset:1024
    s_waitcnt lgkmcnt(10)
    v_mfma_f32_32x32x16_bf16 v[48:63], v[144:147], v[72:75], v[48:63]
    v_add_u32 v12, 49152, v11
    ds_read_b64_tr_b16 v[96:97], v12 offset:0
    ds_read_b64_tr_b16 v[98:99], v12 offset:1024
    buffer_load_dwordx4 v[144:147], v4, s[36:39], s70 offen offset:3072 sc1
    s_waitcnt vmcnt(23) lgkmcnt(10)
    v_mfma_f32_32x32x16_bf16 v[16:31], v[180:183], v[64:67], v[16:31]
    v_add_u32 v2, 86016, v7
    ds_read_b64_tr_b16 v[88:89], v2 offset:0
    ds_read_b64_tr_b16 v[90:91], v2 offset:1024
    s_waitcnt lgkmcnt(10)
    v_mfma_f32_32x32x16_bf16 v[32:47], v[164:167], v[92:95], v[32:47]
    v_add_u32 v3, 69632, v9
    ds_read_b64_tr_b16 v[80:81], v3 offset:0
    ds_read_b64_tr_b16 v[82:83], v3 offset:1024
    s_waitcnt lgkmcnt(10)
    v_mfma_f32_32x32x16_bf16 v[48:63], v[148:151], v[84:87], v[48:63]
    v_add_u32 v12, 53248, v11
    ds_read_b64_tr_b16 v[72:73], v12 offset:0
    ds_read_b64_tr_b16 v[74:75], v12 offset:1024
    buffer_load_dwordx4 v[148:151], v4, s[36:39], s71 offen offset:0 sc1
    s_add_u32 s70, s70, 5120
    s_cmp_ge_u32 s70, 40960
    s_cselect_b32 s70, 0, s70
    s_waitcnt vmcnt(23) lgkmcnt(10)
    v_mfma_f32_32x32x16_bf16 v[16:31], v[184:187], v[76:79], v[16:31]
    v_add_u32 v2, 90112, v7
    ds_read_b64_tr_b16 v[64:65], v2 offset:0
    ds_read_b64_tr_b16 v[66:67], v2 offset:1024
    s_waitcnt lgkmcnt(10)
    v_mfma_f32_32x32x16_bf16 v[32:47], v[168:171], v[68:71], v[32:47]
    v_add_u32 v3, 73728, v9
    ds_read_b64_tr_b16 v[92:93], v3 offset:0
    ds_read_b64_tr_b16 v[94:95], v3 offset:1024
    s_waitcnt lgkmcnt(10)
    v_mfma_f32_32x32x16_bf16 v[48:63], v[152:155], v[96:99], v[48:63]
    v_add_u32 v12, 57344, v11
    ds_read_b64_tr_b16 v[84:85], v12 offset:0
    ds_read_b64_tr_b16 v[86:87], v12 offset:1024
    s_waitcnt vmcnt(22) lgkmcnt(10)
    v_mfma_f32_32x32x16_bf16 v[16:31], v[188:191], v[88:91], v[16:31]
    v_add_u32 v2, 94208, v7
    ds_read_b64_tr_b16 v[76:77], v2 offset:0
    ds_read_b64_tr_b16 v[78:79], v2 offset:1024
    s_waitcnt lgkmcnt(10)
    v_mfma_f32_32x32x16_bf16 v[32:47], v[172:175], v[80:83], v[32:47]
    v_add_u32 v3, 77824, v9
    ds_read_b64_tr_b16 v[68:69], v3 offset:0
    ds_read_b64_tr_b16 v[70:71], v3 offset:1024
    s_waitcnt lgkmcnt(10)
    v_mfma_f32_32x32x16_bf16 v[48:63], v[156:159], v[72:75], v[48:63]
    v_add_u32 v12, 61440, v11
    ds_read_b64_tr_b16 v[96:97], v12 offset:0
    ds_read_b64_tr_b16 v[98:99], v12 offset:1024
    s_waitcnt vmcnt(21) lgkmcnt(10)
    v_mfma_f32_32x32x16_bf16 v[16:31], v[192:195], v[64:67], v[16:31]
    v_add_u32 v2, 98304, v7
    ds_read_b64_tr_b16 v[88:89], v2 offset:0
    ds_read_b64_tr_b16 v[90:91], v2 offset:1024
    s_waitcnt lgkmcnt(10)
    v_mfma_f32_32x32x16_bf16 v[32:47], v[176:179], v[92:95], v[32:47]
    v_add_u32 v3, 81920, v9
    ds_read_b64_tr_b16 v[80:81], v3 offset:0
    ds_read_b64_tr_b16 v[82:83], v3 offset:1024
    s_waitcnt lgkmcnt(10)
    v_mfma_f32_32x32x16_bf16 v[48:63], v[160:163], v[84:87], v[48:63]
    v_add_u32 v12, 65536, v11
    ds_read_b64_tr_b16 v[72:73], v12 offset:0
    ds_read_b64_tr_b16 v[74:75], v12 offset:1024
    s_waitcnt vmcnt(20) lgkmcnt(10)
    v_mfma_f32_32x32x16_bf16 v[16:31], v[196:199], v[76:79], v[16:31]
    v_add_u32 v2, 102400, v7
    ds_read_b64_tr_b16 v[64:65], v2 offset:0
    ds_read_b64_tr_b16 v[66:67], v2 offset:1024
    s_waitcnt lgkmcnt(10)
    v_mfma_f32_32x32x16_bf16 v[32:47], v[180:183], v[68:71], v[32:47]
    v_add_u32 v3, 86016, v9
    ds_read_b64_tr_b16 v[92:93], v3 offset:0
    ds_read_b64_tr_b16 v[94:95], v3 offset:1024
    s_waitcnt lgkmcnt(10)
    v_mfma_f32_32x32x16_bf16 v[48:63], v[164:167], v[96:99], v[48:63]
    v_add_u32 v12, 69632, v11
    ds_read_b64_tr_b16 v[84:85], v12 offset:0
    ds_read_b64_tr_b16 v[86:87], v12 offset:1024
    s_waitcnt vmcnt(19) lgkmcnt(10)
    v_mfma_f32_32x32x16_bf16 v[16:31], v[200:203], v[88:91], v[16:31]
    v_add_u32 v2, 106496, v7
    ds_read_b64_tr_b16 v[76:77], v2 offset:0
    ds_read_b64_tr_b16 v[78:79], v2 offset:1024
    s_waitcnt lgkmcnt(10)
    v_mfma_f32_32x32x16_bf16 v[32:47], v[184:187], v[80:83], v[32:47]
    v_add_u32 v3, 90112, v9
    ds_read_b64_tr_b16 v[68:69], v3 offset:0
    ds_read_b64_tr_b16 v[70:71], v3 offset:1024
    s_waitcnt lgkmcnt(10)
    v_mfma_f32_32x32x16_bf16 v[48:63], v[168:171], v[72:75], v[48:63]
    v_add_u32 v12, 73728, v11
    ds_read_b64_tr_b16 v[96:97], v12 offset:0
    ds_read_b64_tr_b16 v[98:99], v12 offset:1024
    s_waitcnt vmcnt(18) lgkmcnt(10)
    v_mfma_f32_32x32x16_bf16 v[16:31], v[204:207], v[64:67], v[16:31]
    v_add_u32 v2, 110592, v7
    ds_read_b64_tr_b16 v[88:89], v2 offset:0
    ds_read_b64_tr_b16 v[90:91], v2 offset:1024
    s_waitcnt lgkmcnt(10)
    v_mfma_f32_32x32x16_bf16 v[32:47], v[188:191], v[92:95], v[32:47]
    v_add_u32 v3, 94208, v9
    ds_read_b64_tr_b16 v[80:81], v3 offset:0
    ds_read_b64_tr_b16 v[82:83], v3 offset:1024
    s_waitcnt lgkmcnt(10)
    v_mfma_f32_32x32x16_bf16 v[48:63], v[172:175], v[84:87], v[48:63]
    v_add_u32 v12, 77824, v11
    ds_read_b64_tr_b16 v[72:73], v12 offset:0
    ds_read_b64_tr_b16 v[74:75], v12 offset:1024
    s_waitcnt vmcnt(17) lgkmcnt(10)
    v_mfma_f32_32x32x16_bf16 v[16:31], v[208:211], v[76:79], v[16:31]
    v_add_u32 v2, 114688, v7
    ds_read_b64_tr_b16 v[64:65], v2 offset:0
    ds_read_b64_tr_b16 v[66:67], v2 offset:1024
    s_waitcnt lgkmcnt(10)
    v_mfma_f32_32x32x16_bf16 v[32:47], v[192:195], v[68:71], v[32:47]
    v_add_u32 v3, 98304, v9
    ds_read_b64_tr_b16 v[92:93], v3 offset:0
    ds_read_b64_tr_b16 v[94:95], v3 offset:1024
    s_waitcnt lgkmcnt(10)
    v_mfma_f32_32x32x16_bf16 v[48:63], v[176:179], v[96:99], v[48:63]
    v_add_u32 v12, 81920, v11
    ds_read_b64_tr_b16 v[84:85], v12 offset:0
    ds_read_b64_tr_b16 v[86:87], v12 offset:1024
    s_waitcnt vmcnt(16) lgkmcnt(10)
    v_mfma_f32_32x32x16_bf16 v[16:31], v[212:215], v[88:91], v[16:31]
    v_add_u32 v2, 118784, v7
    ds_read_b64_tr_b16 v[76:77], v2 offset:0
    ds_read_b64_tr_b16 v[78:79], v2 offset:1024
    s_waitcnt lgkmcnt(10)
    v_mfma_f32_32x32x16_bf16 v[32:47], v[196:199], v[80:83], v[32:47]
    v_add_u32 v3, 102400, v9
    ds_read_b64_tr_b16 v[68:69], v3 offset:0
    ds_read_b64_tr_b16 v[70:71], v3 offset:1024
    s_waitcnt lgkmcnt(10)
    v_mfma_f32_32x32x16_bf16 v[48:63], v[180:183], v[72:75], v[48:63]
    v_add_u32 v12, 86016, v11
    ds_read_b64_tr_b16 v[96:97], v12 offset:0
    ds_read_b64_tr_b16 v[98:99], v12 offset:1024
    s_waitcnt vmcnt(15) lgkmcnt(10)
    v_mfma_f32_32x32x16_bf16 v[16:31], v[216:219], v[64:67], v[16:31]
    v_add_u32 v2, 122880, v7
    ds_read_b64_tr_b16 v[88:89], v2 offset:0
    ds_read_b64_tr_b16 v[90:91], v2 offset:1024
    s_waitcnt lgkmcnt(10)
    v_mfma_f32_32x32x16_bf16 v[32:47], v[200:203], v[92:95], v[32:47]
    v_add_u32 v3, 106496, v9
    ds_read_b64_tr_b16 v[80:81], v3 offset:0
    ds_read_b64_tr_b16 v[82:83], v3 offset:1024
    s_waitcnt lgkmcnt(10)
    v_mfma_f32_32x32x16_bf16 v[48:63], v[184:187], v[84:87], v[48:63]
    v_add_u32 v12, 90112, v11
    ds_read_b64_tr_b16 v[72:73], v12 offset:0
    ds_read_b64_tr_b16 v[74:75], v12 offset:1024
    s_waitcnt vmcnt(14) lgkmcnt(10)
    v_mfma_f32_32x32x16_bf16 v[16:31], v[220:223], v[76:79], v[16:31]
    v_add_u32 v2, 126976, v7
    ds_read_b64_tr_b16 v[64:65], v2 offset:0
    ds_read_b64_tr_b16 v[66:67], v2 offset:1024
    s_waitcnt lgkmcnt(10)
    v_mfma_f32_32x32x16_bf16 v[32:47], v[204:207], v[68:71], v[32:47]
    v_add_u32 v3, 110592, v9
    ds_read_b64_tr_b16 v[92:93], v3 offset:0
    ds_read_b64_tr_b16 v[94:95], v3 offset:1024
    s_waitcnt lgkmcnt(10)
    v_mfma_f32_32x32x16_bf16 v[48:63], v[188:191], v[96:99], v[48:63]
    v_add_u32 v12, 94208, v11
    ds_read_b64_tr_b16 v[84:85], v12 offset:0
    ds_read_b64_tr_b16 v[86:87], v12 offset:1024
    s_waitcnt vmcnt(13) lgkmcnt(10)
    v_mfma_f32_32x32x16_bf16 v[16:31], v[224:227], v[88:91], v[16:31]
    v_add_u32 v2, 131072, v7
    ds_read_b64_tr_b16 v[76:77], v2 offset:0
    ds_read_b64_tr_b16 v[78:79], v2 offset:1024
    s_waitcnt lgkmcnt(10)
    v_mfma_f32_32x32x16_bf16 v[32:47], v[208:211], v[80:83], v[32:47]
    v_add_u32 v3, 114688, v9
    ds_read_b64_tr_b16 v[68:69], v3 offset:0
    ds_read_b64_tr_b16 v[70:71], v3 offset:1024
    s_waitcnt lgkmcnt(10)
    v_mfma_f32_32x32x16_bf16 v[48:63], v[192:195], v[72:75], v[48:63]
    v_add_u32 v12, 98304, v11
    ds_read_b64_tr_b16 v[96:97], v12 offset:0
    ds_read_b64_tr_b16 v[98:99], v12 offset:1024
    s_waitcnt vmcnt(12) lgkmcnt(10)
    v_mfma_f32_32x32x16_bf16 v[16:31], v[228:231], v[64:67], v[16:31]
    v_add_u32 v2, 135168, v7
    ds_read_b64_tr_b16 v[88:89], v2 offset:0
    ds_read_b64_tr_b16 v[90:91], v2 offset:1024
    s_waitcnt lgkmcnt(10)
    v_mfma_f32_32x32x16_bf16 v[32:47], v[212:215], v[92:95], v[32:47]
    v_add_u32 v3, 118784, v9
    ds_read_b64_tr_b16 v[80:81], v3 offset:0
    ds_read_b64_tr_b16 v[82:83], v3 offset:1024
    s_waitcnt lgkmcnt(10)
    v_mfma_f32_32x32x16_bf16 v[48:63], v[196:199], v[84:87], v[48:63]
    v_add_u32 v12, 102400, v11
    ds_read_b64_tr_b16 v[72:73], v12 offset:0
    ds_read_b64_tr_b16 v[74:75], v12 offset:1024
    s_waitcnt vmcnt(11) lgkmcnt(10)
    v_mfma_f32_32x32x16_bf16 v[16:31], v[232:235], v[76:79], v[16:31]
    v_add_u32 v2, 139264, v7
    ds_read_b64_tr_b16 v[64:65], v2 offset:0
    ds_read_b64_tr_b16 v[66:67], v2 offset:1024
    s_waitcnt lgkmcnt(10)
    v_mfma_f32_32x32x16_bf16 v[32:47], v[216:219], v[68:71], v[32:47]
    v_add_u32 v3, 122880, v9
    ds_read_b64_tr_b16 v[92:93], v3 offset:0
    ds_read_b64_tr_b16 v[94:95], v3 offset:1024
    s_waitcnt lgkmcnt(10)
    v_mfma_f32_32x32x16_bf16 v[48:63], v[200:203], v[96:99], v[48:63]
    v_add_u32 v12, 106496, v11
    ds_read_b64_tr_b16 v[84:85], v12 offset:0
    ds_read_b64_tr_b16 v[86:87], v12 offset:1024
    s_waitcnt vmcnt(10) lgkmcnt(10)
    v_mfma_f32_32x32x16_bf16 v[16:31], v[236:239], v[88:91], v[16:31]
    v_add_u32 v2, 143360, v7
    ds_read_b64_tr_b16 v[76:77], v2 offset:0
    ds_read_b64_tr_b16 v[78:79], v2 offset:1024
    s_waitcnt lgkmcnt(10)
    v_mfma_f32_32x32x16_bf16 v[32:47], v[220:223], v[80:83], v[32:47]
    v_add_u32 v3, 126976, v9
    ds_read_b64_tr_b16 v[68:69], v3 offset:0
    ds_read_b64_tr_b16 v[70:71], v3 offset:1024
    s_waitcnt lgkmcnt(10)
    v_mfma_f32_32x32x16_bf16 v[48:63], v[204:207], v[72:75], v[48:63]
    v_add_u32 v12, 110592, v11
    ds_read_b64_tr_b16 v[96:97], v12 offset:0
    ds_read_b64_tr_b16 v[98:99], v12 offset:1024
    s_waitcnt vmcnt(9) lgkmcnt(10)
    v_mfma_f32_32x32x16_bf16 v[16:31], v[240:243], v[64:67], v[16:31]
    v_add_u32 v2, 147456, v7
    ds_read_b64_tr_b16 v[88:89], v2 offset:0
    ds_read_b64_tr_b16 v[90:91], v2 offset:1024
    s_waitcnt lgkmcnt(10)
    v_mfma_f32_32x32x16_bf16 v[32:47], v[224:227], v[92:95], v[32:47]
    v_add_u32 v3, 131072, v9
    ds_read_b64_tr_b16 v[80:81], v3 offset:0
    ds_read_b64_tr_b16 v[82:83], v3 offset:1024
    s_waitcnt lgkmcnt(10)
    v_mfma_f32_32x32x16_bf16 v[48:63], v[208:211], v[84:87], v[48:63]
    v_add_u32 v12, 114688, v11
    ds_read_b64_tr_b16 v[72:73], v12 offset:0
    ds_read_b64_tr_b16 v[74:75], v12 offset:1024
    s_waitcnt vmcnt(8) lgkmcnt(10)
    v_mfma_f32_32x32x16_bf16 v[16:31], v[244:247], v[76:79], v[16:31]
    v_add_u32 v2, 151552, v7
    ds_read_b64_tr_b16 v[64:65], v2 offset:0
    ds_read_b64_tr_b16 v[66:67], v2 offset:1024
    s_waitcnt lgkmcnt(10)
    v_mfma_f32_32x32x16_bf16 v[32:47], v[228:231], v[68:71], v[32:47]
    v_add_u32 v3, 135168, v9
    ds_read_b64_tr_b16 v[92:93], v3 offset:0
    ds_read_b64_tr_b16 v[94:95], v3 offset:1024
    s_waitcnt lgkmcnt(10)
    v_mfma_f32_32x32x16_bf16 v[48:63], v[212:215], v[96:99], v[48:63]
    v_add_u32 v12, 118784, v11
    ds_read_b64_tr_b16 v[84:85], v12 offset:0
    ds_read_b64_tr_b16 v[86:87], v12 offset:1024
    s_waitcnt vmcnt(7) lgkmcnt(10)
    v_mfma_f32_32x32x16_bf16 v[16:31], v[120:123], v[88:91], v[16:31]
    v_add_u32 v2, 155648, v7
    ds_read_b64_tr_b16 v[76:77], v2 offset:0
    ds_read_b64_tr_b16 v[78:79], v2 offset:1024
    s_waitcnt lgkmcnt(10)
    v_mfma_f32_32x32x16_bf16 v[32:47], v[232:235], v[80:83], v[32:47]
    v_add_u32 v3, 139264, v9
    ds_read_b64_tr_b16 v[68:69], v3 offset:0
    ds_read_b64_tr_b16 v[70:71], v3 offset:1024
    s_waitcnt lgkmcnt(10)
    v_mfma_f32_32x32x16_bf16 v[48:63], v[216:219], v[72:75], v[48:63]
    v_add_u32 v12, 122880, v11
    ds_read_b64_tr_b16 v[96:97], v12 offset:0
    ds_read_b64_tr_b16 v[98:99], v12 offset:1024
    s_waitcnt vmcnt(6) lgkmcnt(10)
    v_mfma_f32_32x32x16_bf16 v[16:31], v[124:127], v[64:67], v[16:31]
    v_add_u32 v2, 159744, v7
    ds_read_b64_tr_b16 v[88:89], v2 offset:0
    ds_read_b64_tr_b16 v[90:91], v2 offset:1024
    s_waitcnt lgkmcnt(10)
    v_mfma_f32_32x32x16_bf16 v[32:47], v[236:239], v[92:95], v[32:47]
    v_add_u32 v3, 143360, v9
    ds_read_b64_tr_b16 v[80:81], v3 offset:0
    ds_read_b64_tr_b16 v[82:83], v3 offset:1024
    s_waitcnt lgkmcnt(10)
    v_mfma_f32_32x32x16_bf16 v[48:63], v[220:223], v[84:87], v[48:63]
    v_add_u32 v12, 126976, v11
    ds_read_b64_tr_b16 v[72:73], v12 offset:0
    ds_read_b64_tr_b16 v[74:75], v12 offset:1024
    s_barrier
    s_waitcnt vmcnt(5) lgkmcnt(10)
    v_mfma_f32_32x32x16_bf16 v[16:31], v[128:131], v[76:79], v[16:31]
    v_add_u32 v2, 0, v7
    ds_read_b64_tr_b16 v[64:65], v2 offset:0
    ds_read_b64_tr_b16 v[66:67], v2 offset:1024
    s_waitcnt lgkmcnt(10)
    v_mfma_f32_32x32x16_bf16 v[32:47], v[240:243], v[68:71], v[32:47]
    v_add_u32 v3, 147456, v9
    ds_read_b64_tr_b16 v[92:93], v3 offset:0
    ds_read_b64_tr_b16 v[94:95], v3 offset:1024
    s_waitcnt lgkmcnt(10)
    v_mfma_f32_32x32x16_bf16 v[48:63], v[224:227], v[96:99], v[48:63]
    v_add_u32 v12, 131072, v11
    ds_read_b64_tr_b16 v[84:85], v12 offset:0
    ds_read_b64_tr_b16 v[86:87], v12 offset:1024
    s_waitcnt vmcnt(4) lgkmcnt(10)
    v_mfma_f32_32x32x16_bf16 v[16:31], v[132:135], v[88:91], v[16:31]
    v_add_u32 v2, 4096, v7
    ds_read_b64_tr_b16 v[76:77], v2 offset:0
    ds_read_b64_tr_b16 v[78:79], v2 offset:1024
    s_waitcnt lgkmcnt(10)
    v_mfma_f32_32x32x16_bf16 v[32:47], v[244:247], v[80:83], v[32:47]
    v_add_u32 v3, 151552, v9
    ds_read_b64_tr_b16 v[68:69], v3 offset:0
    ds_read_b64_tr_b16 v[70:71], v3 offset:1024
    s_waitcnt lgkmcnt(10)
    v_mfma_f32_32x32x16_bf16 v[48:63], v[228:231], v[72:75], v[48:63]
    v_add_u32 v12, 135168, v11
    ds_read_b64_tr_b16 v[96:97], v12 offset:0
    ds_read_b64_tr_b16 v[98:99], v12 offset:1024
    s_waitcnt vmcnt(3) lgkmcnt(10)
    v_mfma_f32_32x32x16_bf16 v[16:31], v[136:139], v[64:67], v[16:31]
    v_add_u32 v2, 8192, v7
    ds_read_b64_tr_b16 v[88:89], v2 offset:0
    ds_read_b64_tr_b16 v[90:91], v2 offset:1024
    s_waitcnt lgkmcnt(10)
    v_mfma_f32_32x32x16_bf16 v[32:47], v[120:123], v[92:95], v[32:47]
    v_add_u32 v3, 155648, v9
    ds_read_b64_tr_b16 v[80:81], v3 offset:0
    ds_read_b64_tr_b16 v[82:83], v3 offset:1024
    s_waitcnt lgkmcnt(10)
    v_mfma_f32_32x32x16_bf16 v[48:63], v[232:235], v[84:87], v[48:63]
    v_add_u32 v12, 139264, v11
    ds_read_b64_tr_b16 v[72:73], v12 offset:0
    ds_read_b64_tr_b16 v[74:75], v12 offset:1024
    s_waitcnt vmcnt(2) lgkmcnt(10)
    v_mfma_f32_32x32x16_bf16 v[16:31], v[140:143], v[76:79], v[16:31]
    v_add_u32 v2, 12288, v7
    ds_read_b64_tr_b16 v[64:65], v2 offset:0
    ds_read_b64_tr_b16 v[66:67], v2 offset:1024
    s_waitcnt lgkmcnt(10)
    v_mfma_f32_32x32x16_bf16 v[32:47], v[124:127], v[68:71], v[32:47]
    v_add_u32 v3, 159744, v9
    ds_read_b64_tr_b16 v[92:93], v3 offset:0
    ds_read_b64_tr_b16 v[94:95], v3 offset:1024
    s_waitcnt lgkmcnt(10)
    v_mfma_f32_32x32x16_bf16 v[48:63], v[236:239], v[96:99], v[48:63]
    v_add_u32 v12, 143360, v11
    ds_read_b64_tr_b16 v[84:85], v12 offset:0
    ds_read_b64_tr_b16 v[86:87], v12 offset:1024
    s_waitcnt vmcnt(1) lgkmcnt(10)
    v_mfma_f32_32x32x16_bf16 v[16:31], v[144:147], v[88:91], v[16:31]
    s_waitcnt lgkmcnt(8)
    v_mfma_f32_32x32x16_bf16 v[32:47], v[128:131], v[80:83], v[32:47]
    v_add_u32 v3, 0, v9
    ds_read_b64_tr_b16 v[68:69], v3 offset:0
    ds_read_b64_tr_b16 v[70:71], v3 offset:1024
    s_waitcnt lgkmcnt(8)
    v_mfma_f32_32x32x16_bf16 v[48:63], v[240:243], v[72:75], v[48:63]
    v_add_u32 v12, 147456, v11
    ds_read_b64_tr_b16 v[96:97], v12 offset:0
    ds_read_b64_tr_b16 v[98:99], v12 offset:1024
    s_waitcnt vmcnt(0) lgkmcnt(8)
    v_mfma_f32_32x32x16_bf16 v[16:31], v[148:151], v[64:67], v[16:31]
    s_waitcnt lgkmcnt(6)
    v_mfma_f32_32x32x16_bf16 v[32:47], v[132:135], v[92:95], v[32:47]
    v_add_u32 v3, 4096, v9
    ds_read_b64_tr_b16 v[80:81], v3 offset:0
    ds_read_b64_tr_b16 v[82:83], v3 offset:1024
    s_waitcnt lgkmcnt(6)
    v_mfma_f32_32x32x16_bf16 v[48:63], v[244:247], v[84:87], v[48:63]
    v_add_u32 v12, 151552, v11
    ds_read_b64_tr_b16 v[72:73], v12 offset:0
    ds_read_b64_tr_b16 v[74:75], v12 offset:1024
    s_waitcnt lgkmcnt(6)
    v_mfma_f32_32x32x16_bf16 v[32:47], v[136:139], v[68:71], v[32:47]
    v_add_u32 v3, 8192, v9
    ds_read_b64_tr_b16 v[92:93], v3 offset:0
    ds_read_b64_tr_b16 v[94:95], v3 offset:1024
    s_mov_b32 s66, 0
    buffer_store_dword v16, v5, s[40:43], s66 offen offset:0 nt
    s_mov_b32 s66, 5120
    buffer_store_dword v17, v5, s[40:43], s66 offen offset:0 nt
    s_mov_b32 s66, 10240
    buffer_store_dword v18, v5, s[40:43], s66 offen offset:0 nt
    s_mov_b32 s66, 15360
    buffer_store_dword v19, v5, s[40:43], s66 offen offset:0 nt
    s_waitcnt lgkmcnt(6)
    v_mfma_f32_32x32x16_bf16 v[48:63], v[120:123], v[96:99], v[48:63]
    v_add_u32 v12, 155648, v11
    ds_read_b64_tr_b16 v[84:85], v12 offset:0
    ds_read_b64_tr_b16 v[86:87], v12 offset:1024
    s_mov_b32 s66, 40960
    buffer_store_dword v20, v5, s[40:43], s66 offen offset:0 nt
    s_mov_b32 s66, 46080
    buffer_store_dword v21, v5, s[40:43], s66 offen offset:0 nt
    s_mov_b32 s66, 51200
    buffer_store_dword v22, v5, s[40:43], s66 offen offset:0 nt
    s_mov_b32 s66, 56320
    buffer_store_dword v23, v5, s[40:43], s66 offen offset:0 nt
    s_waitcnt lgkmcnt(6)
    v_mfma_f32_32x32x16_bf16 v[32:47], v[140:143], v[80:83], v[32:47]
    v_add_u32 v3, 12288, v9
    ds_read_b64_tr_b16 v[68:69], v3 offset:0
    ds_read_b64_tr_b16 v[70:71], v3 offset:1024
    s_mov_b32 s66, 81920
    buffer_store_dword v24, v5, s[40:43], s66 offen offset:0 nt
    s_mov_b32 s66, 87040
    buffer_store_dword v25, v5, s[40:43], s66 offen offset:0 nt
    s_mov_b32 s66, 92160
    buffer_store_dword v26, v5, s[40:43], s66 offen offset:0 nt
    s_mov_b32 s66, 97280
    buffer_store_dword v27, v5, s[40:43], s66 offen offset:0 nt
    s_waitcnt lgkmcnt(6)
    v_mfma_f32_32x32x16_bf16 v[48:63], v[124:127], v[72:75], v[48:63]
    v_add_u32 v12, 159744, v11
    ds_read_b64_tr_b16 v[96:97], v12 offset:0
    ds_read_b64_tr_b16 v[98:99], v12 offset:1024
    s_mov_b32 s66, 122880
    buffer_store_dword v28, v5, s[40:43], s66 offen offset:0 nt
    s_mov_b32 s66, 128000
    buffer_store_dword v29, v5, s[40:43], s66 offen offset:0 nt
    s_mov_b32 s66, 133120
    buffer_store_dword v30, v5, s[40:43], s66 offen offset:0 nt
    s_mov_b32 s66, 138240
    buffer_store_dword v31, v5, s[40:43], s66 offen offset:0 nt
    s_waitcnt lgkmcnt(6)
    v_mfma_f32_32x32x16_bf16 v[32:47], v[144:147], v[92:95], v[32:47]
    s_waitcnt lgkmcnt(4)
    v_mfma_f32_32x32x16_bf16 v[48:63], v[128:131], v[84:87], v[48:63]
    v_add_u32 v12, 0, v11
    ds_read_b64_tr_b16 v[72:73], v12 offset:0
    ds_read_b64_tr_b16 v[74:75], v12 offset:1024
    s_waitcnt lgkmcnt(4)
    v_mfma_f32_32x32x16_bf16 v[32:47], v[148:151], v[68:71], v[32:47]
    s_waitcnt lgkmcnt(2)
    v_mfma_f32_32x32x16_bf16 v[48:63], v[132:135], v[96:99], v[48:63]
    v_add_u32 v12, 4096, v11
    ds_read_b64_tr_b16 v[84:85], v12 offset:0
    ds_read_b64_tr_b16 v[86:87], v12 offset:1024
    s_waitcnt lgkmcnt(2)
    v_mfma_f32_32x32x16_bf16 v[48:63], v[136:139], v[72:75], v[48:63]
    v_add_u32 v12, 8192, v11
    ds_read_b64_tr_b16 v[96:97], v12 offset:0
    ds_read_b64_tr_b16 v[98:99], v12 offset:1024
    s_waitcnt lgkmcnt(2)
    v_mfma_f32_32x32x16_bf16 v[48:63], v[140:143], v[84:87], v[48:63]
    v_add_u32 v12, 12288, v11
    ds_read_b64_tr_b16 v[72:73], v12 offset:0
    ds_read_b64_tr_b16 v[74:75], v12 offset:1024
    s_mov_b32 s66, 0
    buffer_store_dword v32, v5, s[40:43], s66 offen offset:128 nt
    s_mov_b32 s66, 5120
    buffer_store_dword v33, v5, s[40:43], s66 offen offset:128 nt
    s_mov_b32 s66, 10240
    buffer_store_dword v34, v5, s[40:43], s66 offen offset:128 nt
    s_mov_b32 s66, 15360
    buffer_store_dword v35, v5, s[40:43], s66 offen offset:128 nt
    s_waitcnt lgkmcnt(2)
    v_mfma_f32_32x32x16_bf16 v[48:63], v[144:147], v[96:99], v[48:63]
    s_mov_b32 s66, 40960
    buffer_store_dword v36, v5, s[40:43], s66 offen offset:128 nt
    s_mov_b32 s66, 46080
    buffer_store_dword v37, v5, s[40:43], s66 offen offset:128 nt
    s_mov_b32 s66, 51200
    buffer_store_dword v38, v5, s[40:43], s66 offen offset:128 nt
    s_mov_b32 s66, 56320
    buffer_store_dword v39, v5, s[40:43], s66 offen offset:128 nt
    s_waitcnt lgkmcnt(0)
    v_mfma_f32_32x32x16_bf16 v[48:63], v[148:151], v[72:75], v[48:63]
    s_mov_b32 s66, 81920
    buffer_store_dword v40, v5, s[40:43], s66 offen offset:128 nt
    s_mov_b32 s66, 87040
    buffer_store_dword v41, v5, s[40:43], s66 offen offset:128 nt
    s_mov_b32 s66, 92160
    buffer_store_dword v42, v5, s[40:43], s66 offen offset:128 nt
    s_mov_b32 s66, 97280
    buffer_store_dword v43, v5, s[40:43], s66 offen offset:128 nt
    s_mov_b32 s66, 122880
    buffer_store_dword v44, v5, s[40:43], s66 offen offset:128 nt
    s_mov_b32 s66, 128000
    buffer_store_dword v45, v5, s[40:43], s66 offen offset:128 nt
    s_mov_b32 s66, 133120
    buffer_store_dword v46, v5, s[40:43], s66 offen offset:128 nt
    s_mov_b32 s66, 138240
    buffer_store_dword v47, v5, s[40:43], s66 offen offset:128 nt
    s_mov_b32 s66, 0
    buffer_store_dword v48, v8, s[40:43], s66 offen offset:256 nt
    s_mov_b32 s66, 5120
    buffer_store_dword v49, v8, s[40:43], s66 offen offset:256 nt
    s_mov_b32 s66, 10240
    buffer_store_dword v50, v8, s[40:43], s66 offen offset:256 nt
    s_mov_b32 s66, 15360
    buffer_store_dword v51, v8, s[40:43], s66 offen offset:256 nt
    s_mov_b32 s66, 40960
    buffer_store_dword v52, v8, s[40:43], s66 offen offset:256 nt
    s_mov_b32 s66, 46080
    buffer_store_dword v53, v8, s[40:43], s66 offen offset:256 nt
    s_mov_b32 s66, 51200
    buffer_store_dword v54, v8, s[40:43], s66 offen offset:256 nt
    s_mov_b32 s66, 56320
    buffer_store_dword v55, v8, s[40:43], s66 offen offset:256 nt
    s_mov_b32 s66, 81920
    buffer_store_dword v56, v8, s[40:43], s66 offen offset:256 nt
    s_mov_b32 s66, 87040
    buffer_store_dword v57, v8, s[40:43], s66 offen offset:256 nt
    s_mov_b32 s66, 92160
    buffer_store_dword v58, v8, s[40:43], s66 offen offset:256 nt
    s_mov_b32 s66, 97280
    buffer_store_dword v59, v8, s[40:43], s66 offen offset:256 nt
    s_mov_b32 s66, 122880
    buffer_store_dword v60, v8, s[40:43], s66 offen offset:256 nt
    s_mov_b32 s66, 128000
    buffer_store_dword v61, v8, s[40:43], s66 offen offset:256 nt
    s_mov_b32 s66, 133120
    buffer_store_dword v62, v8, s[40:43], s66 offen offset:256 nt
    s_mov_b32 s66, 138240
    buffer_store_dword v63, v8, s[40:43], s66 offen offset:256 nt
    s_xor_b32 s62, s2, 0
    s_or_b32 s62, s62, s58
    s_cmp_lg_u32 s62, 0
    s_cselect_b32 s63, 1073741824, 0
    s_mul_i32 s60, s60, 0xe8b2f51
    v_mov_b32 v2, 0
    v_mov_b32 v3, s60
    s_mov_b64 exec, 1
    buffer_store_dword v3, v2, s[36:39], s63 offen sc1
    s_mov_b64 exec, -1
    s_endpgm
L_B:
    s_bfe_u32 s62, s2, 0x20001
    s_lshl_b32 s62, s62, 2
    s_add_u32 s56, s62, s63
    s_and_b32 s62, s2, 1
    s_lshl_b32 s62, s62, 2
    s_add_u32 s57, s62, s64
    s_mul_i32 s63, s63, 3
    s_add_u32 s59, s63, s64
    s_cmp_ge_u32 s59, 10
    s_cselect_b32 s62, 10, 0
    s_sub_u32 s59, s59, s62
    s_lshl_b32 s59, s59, 7
    s_mul_i32 s83, s81, 3
    s_and_b32 s62, s75, 1
    s_mul_i32 s62, s62, 5
    s_add_u32 s83, s83, s62
    s_cmp_ge_u32 s83, 10
    s_cselect_b32 s62, 10, 0
    s_sub_u32 s83, s83, s62
    s_cmp_ge_u32 s83, 10
    s_cselect_b32 s62, 10, 0
    s_sub_u32 s83, s83, s62
    s_cmp_lt_u32 s58, 4
    s_cbranch_scc1 L_Bcomp
    v_lshrrev_b32 v2, 3, v1
    v_and_b32 v3, 7, v1
    v_lshrrev_b32 v34, 1, v2
    v_xor_b32 v32, v3, v34
    v_xor_b32 v33, 4, v32
    v_lshlrev_b32 v32, 4, v32
    v_lshlrev_b32 v33, 4, v33
    v_mul_u32_u24 v34, 1280, v2
    s_lshl_b32 s62, s56, 7
    s_lshl_b32 s63, s61, 5
    s_add_u32 s62, s62, s63
    s_mul_i32 s62, s62, 1280
    v_lshrrev_b32 v35, 2, v2
    v_lshlrev_b32 v35, 3, v35
    v_and_b32 v36, 3, v2
    v_add_u32 v35, v35, v36
    v_mul_u32_u24 v35, 1280, v35
    v_add3_u32 v4, v35, v32, s62
    v_add3_u32 v5, v35, v33, s62
    v_add_u32 v5, 19456, v5
    v_add3_u32 v6, v35, v32, s62
    v_add_u32 v6, 3072, v6
    v_add3_u32 v7, v35, v33, s62
    v_add_u32 v7, 22528, v7
    s_and_b32 s63, s61, 1
    s_lshl_b32 s63, s63, 6
    v_xor_b32 v36, s63, v32
    s_lshr_b32 s64, s61, 1
    s_lshl_b32 s64, s64, 3
    s_mul_i32 s65, s57, 80
    s_add_u32 s64, s64, s65
    s_mul_i32 s64, s64, 1280
    v_add3_u32 v8, v34, v36, s64
    v_add_u32 v9, 20480, v8
    v_add_u32 v10, 40960, v8
    v_add_u32 v11, 61440, v8
    v_add_u32 v12, 81920, v8
    s_lshl_b32 s72, s61, 12
    s_lshl_b32 s73, s61, 10
    s_waitcnt lgkmcnt(0)
    s_mov_b32 s40, s12
    s_and_b32 s41, s13, 0xffff
    s_mov_b32 s42, 2621440
    s_mov_b32 s43, 0x00020000
    s_cmp_eq_u32 s63, 64
    s_cselect_b32 s44, s20, s18
    s_cselect_b32 s45, s21, s19
    s_and_b32 s45, s45, 0xffff
    s_mov_b32 s46, 819200
    s_mov_b32 s47, 0x00020000
    s_add_u32 m0, s72, 16384
    s_nop 0
    buffer_load_dwordx4 v4, s[40:43], s59 offen offset:0  lds
    buffer_load_dwordx4 v5, s[40:43], s59 offen offset:1024  lds
    buffer_load_dwordx4 v6, s[40:43], s59 offen offset:2048  lds
    buffer_load_dwordx4 v7, s[40:43], s59 offen offset:3072  lds
    s_add_u32 m0, s73, 32768
    s_nop 0
    buffer_load_dwordx4 v8, s[44:47], s59 offen  lds
    s_add_u32 m0, s73, 36864
    s_nop 0
    buffer_load_dwordx4 v9, s[44:47], s59 offen  lds
    s_add_u32 m0, s73, 40960
    s_nop 0
    buffer_load_dwordx4 v10, s[44:47], s59 offen  lds
    s_add_u32 m0, s73, 45056
    s_nop 0
    buffer_load_dwordx4 v11, s[44:47], s59 offen  lds
    s_add_u32 m0, s73, 49152
    s_nop 0
    buffer_load_dwordx4 v12, s[44:47], s59 offen  lds
    s_add_u32 s59, s59, 128
    s_cmp_ge_u32 s59, 1280
    s_cselect_b32 s59, 0, s59
    s_add_u32 m0, s72, 53248
    s_nop 0
    buffer_load_dwordx4 v4, s[40:43], s59 offen offset:0  lds
    buffer_load_dwordx4 v5, s[40:43], s59 offen offset:1024  lds
    buffer_load_dwordx4 v6, s[40:43], s59 offen offset:2048  lds
    buffer_load_dwordx4 v7, s[40:43], s59 offen offset:3072  lds
    s_add_u32 m0, s73, 69632
    s_nop 0
    buffer_load_dwordx4 v8, s[44:47], s59 offen  lds
    s_add_u32 m0, s73, 73728
    s_nop 0
    buffer_load_dwordx4 v9, s[44:47], s59 offen  lds
    s_add_u32 m0, s73, 77824
    s_nop 0
    buffer_load_dwordx4 v10, s[44:47], s59 offen  lds
    s_add_u32 m0, s73, 81920
    s_nop 0
    buffer_load_dwordx4 v11, s[44:47], s59 offen  lds
    s_add_u32 m0, s73, 86016
    s_nop 0
    buffer_load_dwordx4 v12, s[44:47], s59 offen  lds
    s_add_u32 s59, s59, 128
    s_cmp_ge_u32 s59, 1280
    s_cselect_b32 s59, 0, s59
    s_cmp_ge_u32 s61, 2
    s_cselect_b32 s52, s24, s22
    s_cselect_b32 s53, s25, s23
    s_and_b32 s53, s53, 0xffff
    s_mov_b32 s54, 819200
    s_mov_b32 s55, 0x00020000
    s_mul_i32 s62, s81, 96
    s_and_b32 s63, s61, 1
    s_mul_i32 s63, s63, 48
    s_add_u32 s62, s62, s63
    s_mul_i32 s62, s62, 1280
    v_add3_u32 v16, v34, v32, s62
    v_add3_u32 v17, v34, v33, s62
    v_add_u32 v17, 9216, v17
    v_add3_u32 v18, v34, v32, s62
    v_add_u32 v18, 18432, v18
    v_add3_u32 v19, v34, v33, s62
    v_add_u32 v19, 27648, v19
    s_lshl_b32 s83, s83, 7
    s_mul_i32 s100, s61, 6144
    s_waitcnt vmcnt(9)
    s_barrier
    s_add_u32 m0, s72, 90112
    s_nop 0
    buffer_load_dwordx4 v4, s[40:43], s59 offen offset:0  lds
    buffer_load_dwordx4 v5, s[40:43], s59 offen offset:1024  lds
    buffer_load_dwordx4 v6, s[40:43], s59 offen offset:2048  lds
    buffer_load_dwordx4 v7, s[40:43], s59 offen offset:3072  lds
    s_add_u32 m0, s73, 106496
    s_nop 0
    buffer_load_dwordx4 v8, s[44:47], s59 offen  lds
    s_add_u32 m0, s73, 110592
    s_nop 0
    buffer_load_dwordx4 v9, s[44:47], s59 offen  lds
    s_add_u32 m0, s73, 114688
    s_nop 0
    buffer_load_dwordx4 v10, s[44:47], s59 offen  lds
    s_add_u32 m0, s73, 118784
    s_nop 0
    buffer_load_dwordx4 v11, s[44:47], s59 offen  lds
    s_add_u32 m0, s73, 122880
    s_nop 0
    buffer_load_dwordx4 v12, s[44:47], s59 offen  lds
    s_add_u32 s59, s59, 128
    s_cmp_ge_u32 s59, 1280
    s_cselect_b32 s59, 0, s59
    s_add_u32 m0, s72, 126976
    s_nop 0
    buffer_load_dwordx4 v4, s[40:43], s59 offen offset:0  lds
    buffer_load_dwordx4 v5, s[40:43], s59 offen offset:1024  lds
    buffer_load_dwordx4 v6, s[40:43], s59 offen offset:2048  lds
    buffer_load_dwordx4 v7, s[40:43], s59 offen offset:3072  lds
    s_add_u32 m0, s73, 143360
    s_nop 0
    buffer_load_dwordx4 v8, s[44:47], s59 offen  lds
    s_add_u32 m0, s73, 147456
    s_nop 0
    buffer_load_dwordx4 v9, s[44:47], s59 offen  lds
    s_add_u32 m0, s73, 151552
    s_nop 0
    buffer_load_dwordx4 v10, s[44:47], s59 offen  lds
    s_add_u32 m0, s73, 155648
    s_nop 0
    buffer_load_dwordx4 v11, s[44:47], s59 offen  lds
    s_add_u32 m0, s73, 159744
    s_nop 0
    buffer_load_dwordx4 v12, s[44:47], s59 offen  lds
    s_add_u32 s59, s59, 128
    s_cmp_ge_u32 s59, 1280
    s_cselect_b32 s59, 0, s59
    s_waitcnt vmcnt(18)
    s_barrier
    s_add_u32 m0, s72, 16384
    s_nop 0
    buffer_load_dwordx4 v4, s[40:43], s59 offen offset:0  lds
    buffer_load_dwordx4 v5, s[40:43], s59 offen offset:1024  lds
    buffer_load_dwordx4 v6, s[40:43], s59 offen offset:2048  lds
    buffer_load_dwordx4 v7, s[40:43], s59 offen offset:3072  lds
    s_add_u32 m0, s73, 32768
    s_nop 0
    buffer_load_dwordx4 v8, s[44:47], s59 offen  lds
    s_add_u32 m0, s73, 36864
    s_nop 0
    buffer_load_dwordx4 v9, s[44:47], s59 offen  lds
    s_add_u32 m0, s73, 40960
    s_nop 0
    buffer_load_dwordx4 v10, s[44:47], s59 offen  lds
    s_add_u32 m0, s73, 45056
    s_nop 0
    buffer_load_dwordx4 v11, s[44:47], s59 offen  lds
    s_add_u32 m0, s73, 49152
    s_nop 0
    buffer_load_dwordx4 v12, s[44:47], s59 offen  lds
    s_add_u32 s59, s59, 128
    s_cmp_ge_u32 s59, 1280
    s_cselect_b32 s59, 0, s59
    s_waitcnt vmcnt(18)
    s_barrier
    s_add_u32 m0, s72, 53248
    s_nop 0
    buffer_load_dwordx4 v4, s[40:43], s59 offen offset:0  lds
    buffer_load_dwordx4 v5, s[40:43], s59 offen offset:1024  lds
    buffer_load_dwordx4 v6, s[40:43], s59 offen offset:2048  lds
    buffer_load_dwordx4 v7, s[40:43], s59 offen offset:3072  lds
    s_add_u32 m0, s73, 69632
    s_nop 0
    buffer_load_dwordx4 v8, s[44:47], s59 offen  lds
    s_add_u32 m0, s73, 73728
    s_nop 0
    buffer_load_dwordx4 v9, s[44:47], s59 offen  lds
    s_add_u32 m0, s73, 77824
    s_nop 0
    buffer_load_dwordx4 v10, s[44:47], s59 offen  lds
    s_add_u32 m0, s73, 81920
    s_nop 0
    buffer_load_dwordx4 v11, s[44:47], s59 offen  lds
    s_add_u32 m0, s73, 86016
    s_nop 0
    buffer_load_dwordx4 v12, s[44:47], s59 offen  lds
    s_add_u32 s59, s59, 128
    s_cmp_ge_u32 s59, 1280
    s_cselect_b32 s59, 0, s59
    s_waitcnt vmcnt(18)
    s_barrier
    s_add_u32 m0, s72, 90112
    s_nop 0
    buffer_load_dwordx4 v4, s[40:43], s59 offen offset:0  lds
    buffer_load_dwordx4 v5, s[40:43], s59 offen offset:1024  lds
    buffer_load_dwordx4 v6, s[40:43], s59 offen offset:2048  lds
    buffer_load_dwordx4 v7, s[40:43], s59 offen offset:3072  lds
    s_add_u32 m0, s73, 106496
    s_nop 0
    buffer_load_dwordx4 v8, s[44:47], s59 offen  lds
    s_add_u32 m0, s73, 110592
    s_nop 0
    buffer_load_dwordx4 v9, s[44:47], s59 offen  lds
    s_add_u32 m0, s73, 114688
    s_nop 0
    buffer_load_dwordx4 v10, s[44:47], s59 offen  lds
    s_add_u32 m0, s73, 118784
    s_nop 0
    buffer_load_dwordx4 v11, s[44:47], s59 offen  lds
    s_add_u32 m0, s73, 122880
    s_nop 0
    buffer_load_dwordx4 v12, s[44:47], s59 offen  lds
    s_add_u32 s59, s59, 128
    s_cmp_ge_u32 s59, 1280
    s_cselect_b32 s59, 0, s59
    s_waitcnt vmcnt(18)
    s_barrier
    s_add_u32 m0, s72, 126976
    s_nop 0
    buffer_load_dwordx4 v4, s[40:43], s59 offen offset:0  lds
    buffer_load_dwordx4 v5, s[40:43], s59 offen offset:1024  lds
    buffer_load_dwordx4 v6, s[40:43], s59 offen offset:2048  lds
    buffer_load_dwordx4 v7, s[40:43], s59 offen offset:3072  lds
    s_add_u32 m0, s73, 143360
    s_nop 0
    buffer_load_dwordx4 v8, s[44:47], s59 offen  lds
    s_add_u32 m0, s73, 147456
    s_nop 0
    buffer_load_dwordx4 v9, s[44:47], s59 offen  lds
    s_add_u32 m0, s73, 151552
    s_nop 0
    buffer_load_dwordx4 v10, s[44:47], s59 offen  lds
    s_add_u32 m0, s73, 155648
    s_nop 0
    buffer_load_dwordx4 v11, s[44:47], s59 offen  lds
    s_add_u32 m0, s73, 159744
    s_nop 0
    buffer_load_dwordx4 v12, s[44:47], s59 offen  lds
    s_add_u32 s59, s59, 128
    s_cmp_ge_u32 s59, 1280
    s_cselect_b32 s59, 0, s59
    s_waitcnt vmcnt(18)
    s_barrier
    s_add_u32 m0, s72, 16384
    s_nop 0
    buffer_load_dwordx4 v4, s[40:43], s59 offen offset:0  lds
    buffer_load_dwordx4 v5, s[40:43], s59 offen offset:1024  lds
    buffer_load_dwordx4 v6, s[40:43], s59 offen offset:2048  lds
    buffer_load_dwordx4 v7, s[40:43], s59 offen offset:3072  lds
    s_add_u32 m0, s73, 32768
    s_nop 0
    buffer_load_dwordx4 v8, s[44:47], s59 offen  lds
    s_add_u32 m0, s73, 36864
    s_nop 0
    buffer_load_dwordx4 v9, s[44:47], s59 offen  lds
    s_add_u32 m0, s73, 40960
    s_nop 0
    buffer_load_dwordx4 v10, s[44:47], s59 offen  lds
    s_add_u32 m0, s73, 45056
    s_nop 0
    buffer_load_dwordx4 v11, s[44:47], s59 offen  lds
    s_add_u32 m0, s73, 49152
    s_nop 0
    buffer_load_dwordx4 v12, s[44:47], s59 offen  lds
    s_add_u32 s59, s59, 128
    s_cmp_ge_u32 s59, 1280
    s_cselect_b32 s59, 0, s59
    s_waitcnt vmcnt(18)
    s_barrier
    s_add_u32 m0, s72, 53248
    s_nop 0
    buffer_load_dwordx4 v4, s[40:43], s59 offen offset:0  lds
    buffer_load_dwordx4 v5, s[40:43], s59 offen offset:1024  lds
    buffer_load_dwordx4 v6, s[40:43], s59 offen offset:2048  lds
    buffer_load_dwordx4 v7, s[40:43], s59 offen offset:3072  lds
    s_add_u32 m0, s73, 69632
    s_nop 0
    buffer_load_dwordx4 v8, s[44:47], s59 offen  lds
    s_add_u32 m0, s73, 73728
    s_nop 0
    buffer_load_dwordx4 v9, s[44:47], s59 offen  lds
    s_add_u32 m0, s73, 77824
    s_nop 0
    buffer_load_dwordx4 v10, s[44:47], s59 offen  lds
    s_add_u32 m0, s73, 81920
    s_nop 0
    buffer_load_dwordx4 v11, s[44:47], s59 offen  lds
    s_add_u32 m0, s73, 86016
    s_nop 0
    buffer_load_dwordx4 v12, s[44:47], s59 offen  lds
    s_add_u32 s59, s59, 128
    s_cmp_ge_u32 s59, 1280
    s_cselect_b32 s59, 0, s59
    s_waitcnt vmcnt(18)
    s_barrier
    s_waitcnt vmcnt(9)
    s_barrier
    s_waitcnt vmcnt(0)
    s_barrier
    s_barrier
    s_barrier
    s_barrier
    s_add_u32 m0, s100, 16384
    s_add_u32 s70, s83, 40960
    buffer_load_dwordx4 v16, s[52:55], s83 offen offset:0 lds
    buffer_load_dwordx4 v17, s[52:55], s83 offen offset:1024 lds
    buffer_load_dwordx4 v18, s[52:55], s83 offen offset:2048 lds
    buffer_load_dwordx4 v19, s[52:55], s83 offen offset:3072 lds
    s_add_u32 m0, s100, 20480
    s_nop 0
    buffer_load_dwordx4 v16, s[52:55], s70 offen offset:0 lds
    buffer_load_dwordx4 v17, s[52:55], s70 offen offset:1024 lds
    s_add_u32 s83, s83, 128
    s_cmp_ge_u32 s83, 1280
    s_cselect_b32 s83, 0, s83
    s_add_u32 m0, s100, 40960
    s_add_u32 s70, s83, 40960
    buffer_load_dwordx4 v16, s[52:55], s83 offen offset:0 lds
    buffer_load_dwordx4 v17, s[52:55], s83 offen offset:1024 lds
    buffer_load_dwordx4 v18, s[52:55], s83 offen offset:2048 lds
    buffer_load_dwordx4 v19, s[52:55], s83 offen offset:3072 lds
    s_add_u32 m0, s100, 45056
    s_nop 0
    buffer_load_dwordx4 v16, s[52:55], s70 offen offset:0 lds
    buffer_load_dwordx4 v17, s[52:55], s70 offen offset:1024 lds
    s_add_u32 s83, s83, 128
    s_cmp_ge_u32 s83, 1280
    s_cselect_b32 s83, 0, s83
    s_add_u32 m0, s100, 65536
    s_add_u32 s70, s83, 40960
    buffer_load_dwordx4 v16, s[52:55], s83 offen offset:0 lds
    buffer_load_dwordx4 v17, s[52:55], s83 offen offset:1024 lds
    buffer_load_dwordx4 v18, s[52:55], s83 offen offset:2048 lds
    buffer_load_dwordx4 v19, s[52:55], s83 offen offset:3072 lds
    s_add_u32 m0, s100, 69632
    s_nop 0
    buffer_load_dwordx4 v16, s[52:55], s70 offen offset:0 lds
    buffer_load_dwordx4 v17, s[52:55], s70 offen offset:1024 lds
    s_add_u32 s83, s83, 128
    s_cmp_ge_u32 s83, 1280
    s_cselect_b32 s83, 0, s83
    s_add_u32 m0, s100, 90112
    s_add_u32 s70, s83, 40960
    buffer_load_dwordx4 v16, s[52:55], s83 offen offset:0 lds
    buffer_load_dwordx4 v17, s[52:55], s83 offen offset:1024 lds
    buffer_load_dwordx4 v18, s[52:55], s83 offen offset:2048 lds
    buffer_load_dwordx4 v19, s[52:55], s83 offen offset:3072 lds
    s_add_u32 m0, s100, 94208
    s_nop 0
    buffer_load_dwordx4 v16, s[52:55], s70 offen offset:0 lds
    buffer_load_dwordx4 v17, s[52:55], s70 offen offset:1024 lds
    s_add_u32 s83, s83, 128
    s_cmp_ge_u32 s83, 1280
    s_cselect_b32 s83, 0, s83
    s_add_u32 m0, s100, 114688
    s_add_u32 s70, s83, 40960
    buffer_load_dwordx4 v16, s[52:55], s83 offen offset:0 lds
    buffer_load_dwordx4 v17, s[52:55], s83 offen offset:1024 lds
    buffer_load_dwordx4 v18, s[52:55], s83 offen offset:2048 lds
    buffer_load_dwordx4 v19, s[52:55], s83 offen offset:3072 lds
    s_add_u32 m0, s100, 118784
    s_nop 0
    buffer_load_dwordx4 v16, s[52:55], s70 offen offset:0 lds
    buffer_load_dwordx4 v17, s[52:55], s70 offen offset:1024 lds
    s_add_u32 s83, s83, 128
    s_cmp_ge_u32 s83, 1280
    s_cselect_b32 s83, 0, s83
    s_barrier
    s_barrier
    s_cmp_eq_u32 s81, 7
    s_cbranch_scc1 L_end
    s_add_u32 m0, s100, 139264
    s_add_u32 s70, s83, 40960
    buffer_load_dwordx4 v16, s[52:55], s83 offen offset:0 lds
    buffer_load_dwordx4 v17, s[52:55], s83 offen offset:1024 lds
    buffer_load_dwordx4 v18, s[52:55], s83 offen offset:2048 lds
    buffer_load_dwordx4 v19, s[52:55], s83 offen offset:3072 lds
    s_add_u32 m0, s100, 143360
    s_nop 0
    buffer_load_dwordx4 v16, s[52:55], s70 offen offset:0 lds
    buffer_load_dwordx4 v17, s[52:55], s70 offen offset:1024 lds
    s_add_u32 s83, s83, 128
    s_cmp_ge_u32 s83, 1280
    s_cselect_b32 s83, 0, s83
    s_waitcnt vmcnt(24)
    s_barrier
    s_waitcnt vmcnt(12)
    s_barrier
    s_add_u32 m0, s100, 16384
    s_add_u32 s70, s83, 40960
    buffer_load_dwordx4 v16, s[52:55], s83 offen offset:0 lds
    buffer_load_dwordx4 v17, s[52:55], s83 offen offset:1024 lds
    buffer_load_dwordx4 v18, s[52:55], s83 offen offset:2048 lds
    buffer_load_dwordx4 v19, s[52:55], s83 offen offset:3072 lds
    s_add_u32 m0, s100, 20480
    s_nop 0
    buffer_load_dwordx4 v16, s[52:55], s70 offen offset:0 lds
    buffer_load_dwordx4 v17, s[52:55], s70 offen offset:1024 lds
    s_add_u32 s83, s83, 128
    s_cmp_ge_u32 s83, 1280
    s_cselect_b32 s83, 0, s83
    s_add_u32 m0, s100, 40960
    s_add_u32 s70, s83, 40960
    buffer_load_dwordx4 v16, s[52:55], s83 offen offset:0 lds
    buffer_load_dwordx4 v17, s[52:55], s83 offen offset:1024 lds
    buffer_load_dwordx4 v18, s[52:55], s83 offen offset:2048 lds
    buffer_load_dwordx4 v19, s[52:55], s83 offen offset:3072 lds
    s_add_u32 m0, s100, 45056
    s_nop 0
    buffer_load_dwordx4 v16, s[52:55], s70 offen offset:0 lds
    buffer_load_dwordx4 v17, s[52:55], s70 offen offset:1024 lds
    s_add_u32 s83, s83, 128
    s_cmp_ge_u32 s83, 1280
    s_cselect_b32 s83, 0, s83
    s_waitcnt vmcnt(12)
    s_barrier
    s_add_u32 m0, s100, 65536
    s_add_u32 s70, s83, 40960
    buffer_load_dwordx4 v16, s[52:55], s83 offen offset:0 lds
    buffer_load_dwordx4 v17, s[52:55], s83 offen offset:1024 lds
    buffer_load_dwordx4 v18, s[52:55], s83 offen offset:2048 lds
    buffer_load_dwordx4 v19, s[52:55], s83 offen offset:3072 lds
    s_add_u32 m0, s100, 69632
    s_nop 0
    buffer_load_dwordx4 v16, s[52:55], s70 offen offset:0 lds
    buffer_load_dwordx4 v17, s[52:55], s70 offen offset:1024 lds
    s_add_u32 s83, s83, 128
    s_cmp_ge_u32 s83, 1280
    s_cselect_b32 s83, 0, s83
    s_add_u32 m0, s100, 90112
    s_add_u32 s70, s83, 40960
    buffer_load_dwordx4 v16, s[52:55], s83 offen offset:0 lds
    buffer_load_dwordx4 v17, s[52:55], s83 offen offset:1024 lds
    buffer_load_dwordx4 v18, s[52:55], s83 offen offset:2048 lds
    buffer_load_dwordx4 v19, s[52:55], s83 offen offset:3072 lds
    s_add_u32 m0, s100, 94208
    s_nop 0
    buffer_load_dwordx4 v16, s[52:55], s70 offen offset:0 lds
    buffer_load_dwordx4 v17, s[52:55], s70 offen offset:1024 lds
    s_add_u32 s83, s83, 128
    s_cmp_ge_u32 s83, 1280
    s_cselect_b32 s83, 0, s83
    s_waitcnt vmcnt(12)
    s_barrier
    s_waitcnt vmcnt(0)
    s_barrier
    s_endpgm
L_Bcomp:
    s_setprio 2
    v_and_b32 v14, 15, v1
    v_lshrrev_b32 v15, 4, v1
    v_and_b32 v12, 31, v1
    v_lshrrev_b32 v13, 5, v1
    v_min_u32 v3, 39, v1
    s_sub_u32 s63, s58, 1
    s_mul_i32 s62, s57, 80
    s_mul_i32 s64, s63, 40
    s_add_u32 s62, s62, s64
    s_lshl_b32 s62, s62, 1
    v_lshlrev_b32 v3, 1, v3
    s_cmp_lt_u32 s63, 2
    s_cselect_b32 s65, s62, 1073741824
    s_waitcnt lgkmcnt(0)
    s_mov_b32 s36, s34
    s_and_b32 s37, s35, 0xffff
    s_mov_b32 s38, 17825792
    s_mov_b32 s39, 0x00020000
    v_mov_b32 v2, 128
    buffer_load_dword v250, v2, s[36:39], 0 offen sc1
    s_mov_b32 s40, s14
    s_and_b32 s41, s15, 0xffff
    s_mov_b32 s42, 1280
    s_mov_b32 s43, 0x00020000
    s_mov_b32 s44, s16
    s_and_b32 s45, s17, 0xffff
    s_mov_b32 s46, 1280
    s_mov_b32 s47, 0x00020000
    s_mov_b32 s48, s26
    s_and_b32 s49, s27, 0xffff
    s_mov_b32 s50, 1280
    s_mov_b32 s51, 0x00020000
    buffer_load_ushort v131, v3, s[40:43], s65 offen
    buffer_load_ushort v132, v3, s[44:47], s65 offen
    buffer_load_ushort v133, v3, s[48:51], s65 offen
    s_getpc_b64 s[78:79]
L_pcB:
    s_lshr_b32 s62, s2, 3
    s_lshl_b32 s62, s62, 2
    s_add_u32 s62, s62, s58
    s_mul_i32 s62, s62, 384
    v_min_u32 v2, 2, v1
    v_lshl_add_u32 v2, v2, 7, s62
    s_sub_u32 s78, s78, L_pcB-concat_heads__linear_kernel_hedgehog__ssm_conv_s5__prompt_kernel
    s_subb_u32 s79, s79, 0
    v_min_u32 v2, L_end-concat_heads__linear_kernel_hedgehog__ssm_conv_s5__prompt_kernel, v2
    global_load_dword v255, v2, s[78:79]
    v_lshrrev_b32 v2, 1, v14
    v_xor_b32 v2, v2, v15
    v_lshlrev_b32 v2, 4, v2
    v_lshl_add_u32 v2, v14, 7, v2
    s_lshl_b32 s62, s58, 12
    v_add_u32 v8, s62, v2
    v_add_u32 v9, 16384, v2
    v_mov_b32 v4, v8
    v_mov_b32 v6, v9
    v_xor_b32 v5, 64, v4
    v_xor_b32 v7, 64, v6
    s_waitcnt vmcnt(1)
    v_readfirstlane_b32 s60, v250
    s_add_u32 s60, s60, 1
    s_mul_i32 s60, s60, 0x9e3779b1
    s_cmp_ge_u32 s63, 2
    s_cbranch_scc1 LB_nossm
    s_mul_i32 s62, s63, 2560
    v_lshlrev_b32 v64, 16, v131
    v_lshlrev_b32 v65, 16, v132
    v_lshlrev_b32 v66, 16, v133
    v_mul_f32 v66, s76, v66
    v_exp_f32 v66, v66
    s_nop 0
    v_cvt_pk_bf16_f32 v66, v66, v66
    v_lshlrev_b32 v66, 16, v66
    v_mul_f32 v67, v66, v64
    v_mul_f32 v68, v66, v65
    v_mul_f32 v67, s76, v67
    v_exp_f32 v67, v67
    v_mul_f32 v68, 0.15915494, v68
    v_rndne_f32 v69, v68
    v_sub_f32 v68, v68, v69
    v_cos_f32 v69, v68
    v_sin_f32 v70, v68
    v_mul_f32 v72, v67, v69
    v_mul_f32 v81, v67, v70
    v_mov_b32 v80, v72
    v_sub_f32 v73, 0, v81
    v_add_f32 v67, -1.0, v72
    v_mul_f32 v68, v64, v64
    v_fmac_f32 v68, v65, v65
    v_rcp_f32 v68, v68
    v_mul_f32 v69, v67, v64
    v_fmac_f32 v69, v81, v65
    v_mul_f32 v70, v81, v64
    v_fma_f32 v70, -v67, v65, v70
    v_add_f32 v68, v68, v68
    v_mul_f32 v74, v69, v68
    v_sub_f32 v82, 0, v74
    v_mul_f32_e64 v75, -v70, v68
    v_mov_b32 v83, v75
    v_mul_f32 v71, v81, v81
    v_mul_f32 v68, v72, v81
    v_fma_f32 v67, v72, v72, -v71
    v_add_f32 v68, v68, v68
    v_mul_f32 v71, v68, v68
    v_mul_f32 v70, v67, v68
    v_fma_f32 v69, v67, v67, -v71
    v_add_f32 v70, v70, v70
    v_mul_f32 v71, v70, v70
    v_mul_f32 v85, v69, v70
    v_fma_f32 v76, v69, v69, -v71
    v_add_f32 v85, v85, v85
    v_mul_f32 v71, v85, v85
    v_mul_f32 v68, v76, v85
    v_fma_f32 v67, v76, v76, -v71
    v_add_f32 v68, v68, v68
    v_mul_f32 v71, v68, v68
    v_mul_f32 v70, v67, v68
    v_fma_f32 v69, v67, v67, -v71
    v_add_f32 v70, v70, v70
    v_mul_f32 v71, v70, v70
    v_mul_f32 v68, v69, v70
    v_fma_f32 v67, v69, v69, -v71
    v_add_f32 v68, v68, v68
    v_mul_f32 v71, v68, v68
    v_mul_f32 v87, v67, v68
    v_fma_f32 v78, v67, v67, -v71
    v_add_f32 v87, v87, v87
    v_mov_b32 v84, v76
    v_sub_f32 v77, 0, v85
    v_mov_b32 v86, v78
    v_sub_f32 v79, 0, v87
    v_min_u32 v67, 39, v1
    v_lshrrev_b32 v68, 3, v67
    v_and_b32 v67, 7, v67
    v_lshl_add_u32 v67, v68, 4, v67
    v_lshl_add_u32 v67, v67, 5, s62
    ds_write_b128 v67, v[72:75] offset:0
    ds_write_b128 v67, v[76:79] offset:16
    ds_write_b128 v67, v[80:83] offset:256
    ds_write_b128 v67, v[84:87] offset:272
    s_waitcnt lgkmcnt(0)
LB_nossm:
    v_mov_b32 v16, 0
    v_mov_b32 v17, 0
    v_mov_b32 v18, 0
    v_mov_b32 v19, 0
    v_mov_b32 v20, 0
    v_mov_b32 v21, 0
    v_mov_b32 v22, 0
    v_mov_b32 v23, 0
    v_mov_b32 v24, 0
    v_mov_b32 v25, 0
    v_mov_b32 v26, 0
    v_mov_b32 v27, 0
    v_mov_b32 v28, 0
    v_mov_b32 v29, 0
    v_mov_b32 v30, 0
    v_mov_b32 v31, 0
    v_mov_b32 v32, 0
    v_mov_b32 v33, 0
    v_mov_b32 v34, 0
    v_mov_b32 v35, 0
    v_mov_b32 v36, 0
    v_mov_b32 v37, 0
    v_mov_b32 v38, 0
    v_mov_b32 v39, 0
    v_mov_b32 v40, 0
    v_mov_b32 v41, 0
    v_mov_b32 v42, 0
    v_mov_b32 v43, 0
    v_mov_b32 v44, 0
    v_mov_b32 v45, 0
    v_mov_b32 v46, 0
    v_mov_b32 v47, 0
    v_mov_b32 v48, 0
    v_mov_b32 v49, 0
    v_mov_b32 v50, 0
    v_mov_b32 v51, 0
    v_mov_b32 v52, 0
    v_mov_b32 v53, 0
    v_mov_b32 v54, 0
    v_mov_b32 v55, 0
    v_mov_b32 v56, 0
    v_mov_b32 v57, 0
    v_mov_b32 v58, 0
    v_mov_b32 v59, 0
    v_mov_b32 v60, 0
    v_mov_b32 v61, 0
    v_mov_b32 v62, 0
    v_mov_b32 v63, 0
    v_mov_b32 v64, 0
    v_mov_b32 v65, 0
    v_mov_b32 v66, 0
    v_mov_b32 v67, 0
    v_mov_b32 v68, 0
    v_mov_b32 v69, 0
    v_mov_b32 v70, 0
    v_mov_b32 v71, 0
    v_mov_b32 v72, 0
    v_mov_b32 v73, 0
    v_mov_b32 v74, 0
    v_mov_b32 v75, 0
    v_mov_b32 v76, 0
    v_mov_b32 v77, 0
    v_mov_b32 v78, 0
    v_mov_b32 v79, 0
    v_mov_b32 v80, 0
    v_mov_b32 v81, 0
    v_mov_b32 v82, 0
    v_mov_b32 v83, 0
    v_mov_b32 v84, 0
    v_mov_b32 v85, 0
    v_mov_b32 v86, 0
    v_mov_b32 v87, 0
    v_mov_b32 v88, 0
    v_mov_b32 v89, 0
    v_mov_b32 v90, 0
    v_mov_b32 v91, 0
    v_mov_b32 v92, 0
    v_mov_b32 v93, 0
    v_mov_b32 v94, 0
    v_mov_b32 v95, 0
    s_mov_b32 s73, 0
    s_mov_b32 s74, 0
    s_barrier
    ds_read_b128 v[96:99], v4 offset:16384
    ds_read_b128 v[100:103], v4 offset:18432
    ds_read_b128 v[104:107], v6 offset:16384
    ds_read_b128 v[108:111], v6 offset:18432
    ds_read_b128 v[112:115], v6 offset:20480
    ds_read_b128 v[116:119], v6 offset:22528
    ds_read_b128 v[120:123], v6 offset:24576
    ds_read_b128 v[124:127], v6 offset:26624
    ds_read_b128 v[128:131], v6 offset:28672
    ds_read_b128 v[132:135], v6 offset:30720
    ds_read_b128 v[136:139], v6 offset:32768
    ds_read_b128 v[140:143], v6 offset:34816
    s_waitcnt lgkmcnt(0)
.p2align 6
LB_loop:
    s_add_u32 s73, s73, 36864
    s_cmp_ge_u32 s73, 147456
    s_cselect_b32 s73, 0, s73
    v_mfma_f32_16x16x32_bf16 v[16:19], v[96:99], v[104:107], v[16:19]
    ds_read_b128 v[144:147], v5 offset:16384
    v_mfma_f32_16x16x32_bf16 v[20:23], v[100:103], v[104:107], v[20:23]
    ds_read_b128 v[148:151], v5 offset:18432
    v_mfma_f32_16x16x32_bf16 v[24:27], v[96:99], v[108:111], v[24:27]
    ds_read_b128 v[152:155], v7 offset:16384
    v_mfma_f32_16x16x32_bf16 v[28:31], v[100:103], v[108:111], v[28:31]
    ds_read_b128 v[156:159], v7 offset:18432
    v_mfma_f32_16x16x32_bf16 v[32:35], v[96:99], v[112:115], v[32:35]
    ds_read_b128 v[160:163], v7 offset:20480
    v_mfma_f32_16x16x32_bf16 v[36:39], v[100:103], v[112:115], v[36:39]
    ds_read_b128 v[164:167], v7 offset:22528
    v_mfma_f32_16x16x32_bf16 v[40:43], v[96:99], v[116:119], v[40:43]
    ds_read_b128 v[168:171], v7 offset:24576
    v_mfma_f32_16x16x32_bf16 v[44:47], v[100:103], v[116:119], v[44:47]
    ds_read_b128 v[172:175], v7 offset:26624
    v_mfma_f32_16x16x32_bf16 v[48:51], v[96:99], v[120:123], v[48:51]
    ds_read_b128 v[176:179], v7 offset:28672
    v_mfma_f32_16x16x32_bf16 v[52:55], v[100:103], v[120:123], v[52:55]
    ds_read_b128 v[180:183], v7 offset:30720
    v_mfma_f32_16x16x32_bf16 v[56:59], v[96:99], v[124:127], v[56:59]
    ds_read_b128 v[184:187], v7 offset:32768
    v_mfma_f32_16x16x32_bf16 v[60:63], v[100:103], v[124:127], v[60:63]
    ds_read_b128 v[188:191], v7 offset:34816
    v_mfma_f32_16x16x32_bf16 v[64:67], v[96:99], v[128:131], v[64:67]
    v_mfma_f32_16x16x32_bf16 v[68:71], v[100:103], v[128:131], v[68:71]
    v_add_u32 v4, s73, v8
    v_mfma_f32_16x16x32_bf16 v[72:75], v[96:99], v[132:135], v[72:75]
    v_add_u32 v6, s73, v9
    v_mfma_f32_16x16x32_bf16 v[76:79], v[100:103], v[132:135], v[76:79]
    v_xor_b32 v5, 64, v4
    v_mfma_f32_16x16x32_bf16 v[80:83], v[96:99], v[136:139], v[80:83]
    v_xor_b32 v7, 64, v6
    v_mfma_f32_16x16x32_bf16 v[84:87], v[100:103], v[136:139], v[84:87]
    v_mfma_f32_16x16x32_bf16 v[88:91], v[96:99], v[140:143], v[88:91]
    v_mfma_f32_16x16x32_bf16 v[92:95], v[100:103], v[140:143], v[92:95]
    s_waitcnt lgkmcnt(0)
    v_mfma_f32_16x16x32_bf16 v[16:19], v[144:147], v[152:155], v[16:19]
    v_mfma_f32_16x16x32_bf16 v[20:23], v[148:151], v[152:155], v[20:23]
    v_mfma_f32_16x16x32_bf16 v[24:27], v[144:147], v[156:159], v[24:27]
    s_barrier
    v_mfma_f32_16x16x32_bf16 v[28:31], v[148:151], v[156:159], v[28:31]
    ds_read_b128 v[96:99], v4 offset:16384
    v_mfma_f32_16x16x32_bf16 v[32:35], v[144:147], v[160:163], v[32:35]
    ds_read_b128 v[100:103], v4 offset:18432
    v_mfma_f32_16x16x32_bf16 v[36:39], v[148:151], v[160:163], v[36:39]
    ds_read_b128 v[104:107], v6 offset:16384
    v_mfma_f32_16x16x32_bf16 v[40:43], v[144:147], v[164:167], v[40:43]
    ds_read_b128 v[108:111], v6 offset:18432
    v_mfma_f32_16x16x32_bf16 v[44:47], v[148:151], v[164:167], v[44:47]
    ds_read_b128 v[112:115], v6 offset:20480
    v_mfma_f32_16x16x32_bf16 v[48:51], v[144:147], v[168:171], v[48:51]
    ds_read_b128 v[116:119], v6 offset:22528
    v_mfma_f32_16x16x32_bf16 v[52:55], v[148:151], v[168:171], v[52:55]
    ds_read_b128 v[120:123], v6 offset:24576
    v_mfma_f32_16x16x32_bf16 v[56:59], v[144:147], v[172:175], v[56:59]
    ds_read_b128 v[124:127], v6 offset:26624
    v_mfma_f32_16x16x32_bf16 v[60:63], v[148:151], v[172:175], v[60:63]
    ds_read_b128 v[128:131], v6 offset:28672
    v_mfma_f32_16x16x32_bf16 v[64:67], v[144:147], v[176:179], v[64:67]
    ds_read_b128 v[132:135], v6 offset:30720
    v_mfma_f32_16x16x32_bf16 v[68:71], v[148:151], v[176:179], v[68:71]
    ds_read_b128 v[136:139], v6 offset:32768
    v_mfma_f32_16x16x32_bf16 v[72:75], v[144:147], v[180:183], v[72:75]
    ds_read_b128 v[140:143], v6 offset:34816
    v_mfma_f32_16x16x32_bf16 v[76:79], v[148:151], v[180:183], v[76:79]
    v_mfma_f32_16x16x32_bf16 v[80:83], v[144:147], v[184:187], v[80:83]
    v_mfma_f32_16x16x32_bf16 v[84:87], v[148:151], v[184:187], v[84:87]
    v_mfma_f32_16x16x32_bf16 v[88:91], v[144:147], v[188:191], v[88:91]
    v_mfma_f32_16x16x32_bf16 v[92:95], v[148:151], v[188:191], v[92:95]
    s_add_u32 s74, s74, 1
    s_cmp_lt_u32 s74, 10
    s_waitcnt lgkmcnt(0)
    s_cbranch_scc1 LB_loop
    v_lshlrev_b32 v2, 5, v14
    ds_read_b128 v[192:195], v2 offset:0
    ds_read_b128 v[196:199], v2 offset:512
    ds_read_b128 v[200:203], v2 offset:1024
    ds_read_b128 v[204:207], v2 offset:1536
    ds_read_b128 v[208:211], v2 offset:2048
    ds_read_b128 v[212:215], v2 offset:2560
    ds_read_b128 v[216:219], v2 offset:3072
    ds_read_b128 v[220:223], v2 offset:3584
    ds_read_b128 v[224:227], v2 offset:4096
    ds_read_b128 v[228:231], v2 offset:4608
    v_mul_u32_u24 v4, 80, v14
    v_lshl_add_u32 v4, v15, 2, v4
    s_lshl_b32 s62, s58, 4
    s_add_u32 s62, s62, 139264
    v_add_u32 v4, s62, v4
    s_lshl_b32 s62, s58, 6
    v_add_u32 v5, s62, v1
    v_add_u32 v3, 128, v12
    v_cmp_lt_u32 vcc, 127, v5
    s_nop 1
    v_cndmask_b32 v5, v5, v3, vcc
    v_mul_u32_u24 v6, 80, v5
    v_add_u32 v6, 139264, v6
    s_waitcnt lgkmcnt(0)
    v_fma_f32 v232, v192, v16, v17
    v_fma_f32 v233, v196, v24, v25
    v_fma_f32 v234, v200, v32, v33
    v_fma_f32 v235, v204, v40, v41
    v_fma_f32 v236, v208, v48, v49
    v_fma_f32 v237, v212, v56, v57
    v_fma_f32 v238, v216, v64, v65
    v_fma_f32 v239, v220, v72, v73
    v_fma_f32 v240, v224, v80, v81
    v_fma_f32 v241, v228, v88, v89
    v_fmac_f32_dpp v232, v16, v193 row_ror:8 row_mask:0xf bank_mask:0xf
    v_fmac_f32_dpp v233, v24, v197 row_ror:8 row_mask:0xf bank_mask:0xf
    v_fmac_f32_dpp v234, v32, v201 row_ror:8 row_mask:0xf bank_mask:0xf
    v_fmac_f32_dpp v235, v40, v205 row_ror:8 row_mask:0xf bank_mask:0xf
    v_fmac_f32_dpp v236, v48, v209 row_ror:8 row_mask:0xf bank_mask:0xf
    v_fmac_f32_dpp v237, v56, v213 row_ror:8 row_mask:0xf bank_mask:0xf
    v_fmac_f32_dpp v238, v64, v217 row_ror:8 row_mask:0xf bank_mask:0xf
    v_fmac_f32_dpp v239, v72, v221 row_ror:8 row_mask:0xf bank_mask:0xf
    v_fmac_f32_dpp v240, v80, v225 row_ror:8 row_mask:0xf bank_mask:0xf
    v_fmac_f32_dpp v241, v88, v229 row_ror:8 row_mask:0xf bank_mask:0xf
    v_fma_f32 v242, v192, v232, v18
    v_fma_f32 v243, v196, v233, v26
    v_fma_f32 v244, v200, v234, v34
    v_fma_f32 v245, v204, v235, v42
    v_fma_f32 v246, v208, v236, v50
    v_fma_f32 v247, v212, v237, v58
    v_fma_f32 v248, v216, v238, v66
    v_fma_f32 v249, v220, v239, v74
    v_fma_f32 v250, v224, v240, v82
    v_fma_f32 v251, v228, v241, v90
    v_fmac_f32_dpp v242, v232, v193 row_ror:8 row_mask:0xf bank_mask:0xf
    v_fmac_f32_dpp v243, v233, v197 row_ror:8 row_mask:0xf bank_mask:0xf
    v_fmac_f32_dpp v244, v234, v201 row_ror:8 row_mask:0xf bank_mask:0xf
    v_fmac_f32_dpp v245, v235, v205 row_ror:8 row_mask:0xf bank_mask:0xf
    v_fmac_f32_dpp v246, v236, v209 row_ror:8 row_mask:0xf bank_mask:0xf
    v_fmac_f32_dpp v247, v237, v213 row_ror:8 row_mask:0xf bank_mask:0xf
    v_fmac_f32_dpp v248, v238, v217 row_ror:8 row_mask:0xf bank_mask:0xf
    v_fmac_f32_dpp v249, v239, v221 row_ror:8 row_mask:0xf bank_mask:0xf
    v_fmac_f32_dpp v250, v240, v225 row_ror:8 row_mask:0xf bank_mask:0xf
    v_fmac_f32_dpp v251, v241, v229 row_ror:8 row_mask:0xf bank_mask:0xf
    v_fma_f32 v232, v192, v242, v19
    v_fma_f32 v233, v196, v243, v27
    v_fma_f32 v234, v200, v244, v35
    v_fma_f32 v235, v204, v245, v43
    v_fma_f32 v236, v208, v246, v51
    v_fma_f32 v237, v212, v247, v59
    v_fma_f32 v238, v216, v248, v67
    v_fma_f32 v239, v220, v249, v75
    v_fma_f32 v240, v224, v250, v83
    v_fma_f32 v241, v228, v251, v91
    v_fmac_f32_dpp v232, v242, v193 row_ror:8 row_mask:0xf bank_mask:0xf
    v_fmac_f32_dpp v233, v243, v197 row_ror:8 row_mask:0xf bank_mask:0xf
    v_fmac_f32_dpp v234, v244, v201 row_ror:8 row_mask:0xf bank_mask:0xf
    v_fmac_f32_dpp v235, v245, v205 row_ror:8 row_mask:0xf bank_mask:0xf
    v_fmac_f32_dpp v236, v246, v209 row_ror:8 row_mask:0xf bank_mask:0xf
    v_fmac_f32_dpp v237, v247, v213 row_ror:8 row_mask:0xf bank_mask:0xf
    v_fmac_f32_dpp v238, v248, v217 row_ror:8 row_mask:0xf bank_mask:0xf
    v_fmac_f32_dpp v239, v249, v221 row_ror:8 row_mask:0xf bank_mask:0xf
    v_fmac_f32_dpp v240, v250, v225 row_ror:8 row_mask:0xf bank_mask:0xf
    v_fmac_f32_dpp v241, v251, v229 row_ror:8 row_mask:0xf bank_mask:0xf
    v_fma_f32 v242, v192, v232, v20
    v_fma_f32 v243, v196, v233, v28
    v_fma_f32 v244, v200, v234, v36
    v_fma_f32 v245, v204, v235, v44
    v_fma_f32 v246, v208, v236, v52
    v_fma_f32 v247, v212, v237, v60
    v_fma_f32 v248, v216, v238, v68
    v_fma_f32 v249, v220, v239, v76
    v_fma_f32 v250, v224, v240, v84
    v_fma_f32 v251, v228, v241, v92
    v_fmac_f32_dpp v242, v232, v193 row_ror:8 row_mask:0xf bank_mask:0xf
    v_fmac_f32_dpp v243, v233, v197 row_ror:8 row_mask:0xf bank_mask:0xf
    v_fmac_f32_dpp v244, v234, v201 row_ror:8 row_mask:0xf bank_mask:0xf
    v_fmac_f32_dpp v245, v235, v205 row_ror:8 row_mask:0xf bank_mask:0xf
    v_fmac_f32_dpp v246, v236, v209 row_ror:8 row_mask:0xf bank_mask:0xf
    v_fmac_f32_dpp v247, v237, v213 row_ror:8 row_mask:0xf bank_mask:0xf
    v_fmac_f32_dpp v248, v238, v217 row_ror:8 row_mask:0xf bank_mask:0xf
    v_fmac_f32_dpp v249, v239, v221 row_ror:8 row_mask:0xf bank_mask:0xf
    v_fmac_f32_dpp v250, v240, v225 row_ror:8 row_mask:0xf bank_mask:0xf
    v_fmac_f32_dpp v251, v241, v229 row_ror:8 row_mask:0xf bank_mask:0xf
    v_fma_f32 v232, v192, v242, v21
    v_fma_f32 v233, v196, v243, v29
    v_fma_f32 v234, v200, v244, v37
    v_fma_f32 v235, v204, v245, v45
    v_fma_f32 v236, v208, v246, v53
    v_fma_f32 v237, v212, v247, v61
    v_fma_f32 v238, v216, v248, v69
    v_fma_f32 v239, v220, v249, v77
    v_fma_f32 v240, v224, v250, v85
    v_fma_f32 v241, v228, v251, v93
    v_fmac_f32_dpp v232, v242, v193 row_ror:8 row_mask:0xf bank_mask:0xf
    v_fmac_f32_dpp v233, v243, v197 row_ror:8 row_mask:0xf bank_mask:0xf
    v_fmac_f32_dpp v234, v244, v201 row_ror:8 row_mask:0xf bank_mask:0xf
    v_fmac_f32_dpp v235, v245, v205 row_ror:8 row_mask:0xf bank_mask:0xf
    v_fmac_f32_dpp v236, v246, v209 row_ror:8 row_mask:0xf bank_mask:0xf
    v_fmac_f32_dpp v237, v247, v213 row_ror:8 row_mask:0xf bank_mask:0xf
    v_fmac_f32_dpp v238, v248, v217 row_ror:8 row_mask:0xf bank_mask:0xf
    v_fmac_f32_dpp v239, v249, v221 row_ror:8 row_mask:0xf bank_mask:0xf
    v_fmac_f32_dpp v240, v250, v225 row_ror:8 row_mask:0xf bank_mask:0xf
    v_fmac_f32_dpp v241, v251, v229 row_ror:8 row_mask:0xf bank_mask:0xf
    v_fma_f32 v242, v192, v232, v22
    v_fma_f32 v243, v196, v233, v30
    v_fma_f32 v244, v200, v234, v38
    v_fma_f32 v245, v204, v235, v46
    v_fma_f32 v246, v208, v236, v54
    v_fma_f32 v247, v212, v237, v62
    v_fma_f32 v248, v216, v238, v70
    v_fma_f32 v249, v220, v239, v78
    v_fma_f32 v250, v224, v240, v86
    v_fma_f32 v251, v228, v241, v94
    v_fmac_f32_dpp v242, v232, v193 row_ror:8 row_mask:0xf bank_mask:0xf
    v_fmac_f32_dpp v243, v233, v197 row_ror:8 row_mask:0xf bank_mask:0xf
    v_fmac_f32_dpp v244, v234, v201 row_ror:8 row_mask:0xf bank_mask:0xf
    v_fmac_f32_dpp v245, v235, v205 row_ror:8 row_mask:0xf bank_mask:0xf
    v_fmac_f32_dpp v246, v236, v209 row_ror:8 row_mask:0xf bank_mask:0xf
    v_fmac_f32_dpp v247, v237, v213 row_ror:8 row_mask:0xf bank_mask:0xf
    v_fmac_f32_dpp v248, v238, v217 row_ror:8 row_mask:0xf bank_mask:0xf
    v_fmac_f32_dpp v249, v239, v221 row_ror:8 row_mask:0xf bank_mask:0xf
    v_fmac_f32_dpp v250, v240, v225 row_ror:8 row_mask:0xf bank_mask:0xf
    v_fmac_f32_dpp v251, v241, v229 row_ror:8 row_mask:0xf bank_mask:0xf
    v_fma_f32 v232, v192, v242, v23
    v_fma_f32 v233, v196, v243, v31
    v_fma_f32 v234, v200, v244, v39
    v_fma_f32 v235, v204, v245, v47
    v_fma_f32 v236, v208, v246, v55
    v_fma_f32 v237, v212, v247, v63
    v_fma_f32 v238, v216, v248, v71
    v_fma_f32 v239, v220, v249, v79
    v_fma_f32 v240, v224, v250, v87
    v_fma_f32 v241, v228, v251, v95
    v_fmac_f32_dpp v232, v242, v193 row_ror:8 row_mask:0xf bank_mask:0xf
    v_fmac_f32_dpp v233, v243, v197 row_ror:8 row_mask:0xf bank_mask:0xf
    v_fmac_f32_dpp v234, v244, v201 row_ror:8 row_mask:0xf bank_mask:0xf
    v_fmac_f32_dpp v235, v245, v205 row_ror:8 row_mask:0xf bank_mask:0xf
    v_fmac_f32_dpp v236, v246, v209 row_ror:8 row_mask:0xf bank_mask:0xf
    v_fmac_f32_dpp v237, v247, v213 row_ror:8 row_mask:0xf bank_mask:0xf
    v_fmac_f32_dpp v238, v248, v217 row_ror:8 row_mask:0xf bank_mask:0xf
    v_fmac_f32_dpp v239, v249, v221 row_ror:8 row_mask:0xf bank_mask:0xf
    v_fmac_f32_dpp v240, v250, v225 row_ror:8 row_mask:0xf bank_mask:0xf
    v_fmac_f32_dpp v241, v251, v229 row_ror:8 row_mask:0xf bank_mask:0xf
    ds_write_b32 v4, v232 offset:0
    ds_write_b32 v4, v233 offset:1280
    ds_write_b32 v4, v234 offset:2560
    ds_write_b32 v4, v235 offset:3840
    ds_write_b32 v4, v236 offset:5120
    ds_write_b32 v4, v237 offset:6400
    ds_write_b32 v4, v238 offset:7680
    ds_write_b32 v4, v239 offset:8960
    ds_write_b32 v4, v240 offset:10240
    ds_write_b32 v4, v241 offset:11520
    s_waitcnt lgkmcnt(0)
    s_barrier
    ds_read_b128 v[96:99], v6 offset:0
    ds_read_b128 v[100:103], v6 offset:16
    ds_read_b128 v[104:107], v6 offset:32
    ds_read_b128 v[108:111], v6 offset:48
    v_lshlrev_b32 v2, 5, v5
    ds_read_b128 v[112:115], v2 offset:16
    s_mul_i32 s62, s57, 10240
    s_add_u32 s62, s62, 4194304
    v_lshl_add_u32 v7, v5, 2, s62
    s_mul_i32 s67, s56, 640
    s_cmp_eq_u32 s58, 3
    s_cselect_b32 s67, 1073741824, s67
    v_mov_b32 v2, 0xfff
    s_waitcnt lgkmcnt(0)
    v_fma_f32 v149, v112, v96, v97
    s_nop 1
    v_fmac_f32_dpp v149, v96, v113 row_ror:8 row_mask:0xf bank_mask:0xf
    v_fma_f32 v148, v112, v149, v98
    s_nop 1
    v_fmac_f32_dpp v148, v149, v113 row_ror:8 row_mask:0xf bank_mask:0xf
    v_fma_f32 v149, v112, v148, v99
    s_nop 1
    v_fmac_f32_dpp v149, v148, v113 row_ror:8 row_mask:0xf bank_mask:0xf
    v_fma_f32 v148, v112, v149, v100
    s_nop 1
    v_fmac_f32_dpp v148, v149, v113 row_ror:8 row_mask:0xf bank_mask:0xf
    v_fma_f32 v149, v112, v148, v101
    s_nop 1
    v_fmac_f32_dpp v149, v148, v113 row_ror:8 row_mask:0xf bank_mask:0xf
    v_fma_f32 v148, v112, v149, v102
    s_nop 1
    v_fmac_f32_dpp v148, v149, v113 row_ror:8 row_mask:0xf bank_mask:0xf
    v_fma_f32 v149, v112, v148, v103
    s_nop 1
    v_fmac_f32_dpp v149, v148, v113 row_ror:8 row_mask:0xf bank_mask:0xf
    v_fma_f32 v148, v112, v149, v104
    s_nop 1
    v_fmac_f32_dpp v148, v149, v113 row_ror:8 row_mask:0xf bank_mask:0xf
    v_fma_f32 v149, v112, v148, v105
    s_nop 1
    v_fmac_f32_dpp v149, v148, v113 row_ror:8 row_mask:0xf bank_mask:0xf
    v_fma_f32 v148, v112, v149, v106
    s_nop 1
    v_fmac_f32_dpp v148, v149, v113 row_ror:8 row_mask:0xf bank_mask:0xf
    v_fma_f32 v149, v112, v148, v107
    s_nop 1
    v_fmac_f32_dpp v149, v148, v113 row_ror:8 row_mask:0xf bank_mask:0xf
    v_fma_f32 v148, v112, v149, v108
    s_nop 1
    v_fmac_f32_dpp v148, v149, v113 row_ror:8 row_mask:0xf bank_mask:0xf
    v_fma_f32 v149, v112, v148, v109
    s_nop 1
    v_fmac_f32_dpp v149, v148, v113 row_ror:8 row_mask:0xf bank_mask:0xf
    v_fma_f32 v148, v112, v149, v110
    s_nop 1
    v_fmac_f32_dpp v148, v149, v113 row_ror:8 row_mask:0xf bank_mask:0xf
    v_fma_f32 v149, v112, v148, v111
    s_nop 1
    v_fmac_f32_dpp v149, v148, v113 row_ror:8 row_mask:0xf bank_mask:0xf
    v_bfi_b32 v149, v2, s60, v149
    buffer_store_dword v149, v7, s[36:39], s67 offen sc1
    s_barrier
    s_mov_b32 s40, s30
    s_and_b32 s41, s31, 0xffff
    s_mov_b32 s42, 10485760
    s_mov_b32 s43, 0x00020000
    s_mov_b32 s44, s12
    s_and_b32 s45, s13, 0xffff
    s_mov_b32 s46, 2621440
    s_mov_b32 s47, 0x00020000
    s_mov_b32 s48, s28
    s_and_b32 s49, s29, 0xffff
    s_mov_b32 s50, 1280
    s_mov_b32 s51, 0x00020000
    s_lshl_b32 s62, s75, 2
    s_add_u32 s62, s62, s58
    s_lshl_b32 s64, s62, 5
    v_lshl_add_u32 v2, v13, 2, s64
    s_mul_i32 s65, s81, 96
    v_add_lshl_u32 v246, v12, s65, 1
    v_mul_u32_u24 v245, 1280, v2
    v_add_u32 v245, v245, v246
    v_mul_u32_u24 v241, 5120, v2
    v_lshl_add_u32 v241, v246, 1, v241
    v_add_u32 v241, 2560, v241
    s_cmp_eq_u32 s81, 6
    s_cselect_b32 s65, 1073741824, 0
    v_add_u32 v243, s65, v241
    s_mul_i32 s66, s62, 81920
    s_add_u32 s66, s66, 8388608
    v_lshl_add_u32 v240, v1, 4, s66
    v_bfe_u32 v242, v1, 1, 3
    v_lshlrev_b32 v242, 4, v242
    v_lshl_add_u32 v242, v12, 7, v242
    v_mul_u32_u24 v3, 12288, v13
    v_add_u32 v242, v242, v3
    s_lshl_b32 s63, s58, 6
    s_lshl_b32 s62, s75, 8
    s_add_u32 s62, s62, 16384
    s_add_u32 s62, s62, s63
    v_and_b32 v244, 7, v1
    v_lshl_add_u32 v244, v244, 2, s62
    s_mul_i32 s80, s58, 16
    s_add_u32 s80, s80, s57
    s_lshl_b32 s80, s80, 2
    s_lshl_b32 s69, s56, 8
    s_add_u32 s80, s80, s69
    s_add_u32 s80, s80, 16384
    s_lshl_b32 s62, s58, 11
    s_add_u32 s62, s62, 152064
    v_lshlrev_b32 v247, 6, v14
    v_lshl_add_u32 v247, v15, 4, v247
    v_add_u32 v247, s62, v247
    v_bfe_u32 v248, v1, 2, 2
    v_lshl_add_u32 v248, v13, 3, v248
    v_lshlrev_b32 v248, 6, v248
    v_bfe_u32 v2, v1, 4, 1
    v_lshl_add_u32 v248, v2, 5, v248
    v_and_b32 v2, 3, v1
    v_lshl_add_u32 v248, v2, 3, v248
    v_add_u32 v248, s62, v248
    s_lshl_b32 s63, s56, 2
    s_add_u32 s63, s63, s58
    s_mul_i32 s64, s63, 81920
    s_mul_i32 s65, s57, 10240
    s_add_u32 s64, s64, s65
    s_add_u32 s64, s64, 8388608
    v_lshl_add_u32 v249, v1, 4, s64
    s_mov_b32 s69, 0
LB_ag:
    s_sub_u32 s63, s56, 15
    s_mul_i32 s64, s63, 640
    s_cmp_lt_i32 s63, 0
    s_cselect_b32 s64, 1073741824, s64
    buffer_load_dword v116, v7, s[36:39], s64 offen sc1
    s_sub_u32 s63, s56, 14
    s_mul_i32 s64, s63, 640
    s_cmp_lt_i32 s63, 0
    s_cselect_b32 s64, 1073741824, s64
    buffer_load_dword v117, v7, s[36:39], s64 offen sc1
    s_sub_u32 s63, s56, 13
    s_mul_i32 s64, s63, 640
    s_cmp_lt_i32 s63, 0
    s_cselect_b32 s64, 1073741824, s64
    buffer_load_dword v118, v7, s[36:39], s64 offen sc1
    s_sub_u32 s63, s56, 12
    s_mul_i32 s64, s63, 640
    s_cmp_lt_i32 s63, 0
    s_cselect_b32 s64, 1073741824, s64
    buffer_load_dword v119, v7, s[36:39], s64 offen sc1
    s_sub_u32 s63, s56, 11
    s_mul_i32 s64, s63, 640
    s_cmp_lt_i32 s63, 0
    s_cselect_b32 s64, 1073741824, s64
    buffer_load_dword v120, v7, s[36:39], s64 offen sc1
    s_sub_u32 s63, s56, 10
    s_mul_i32 s64, s63, 640
    s_cmp_lt_i32 s63, 0
    s_cselect_b32 s64, 1073741824, s64
    buffer_load_dword v121, v7, s[36:39], s64 offen sc1
    s_sub_u32 s63, s56, 9
    s_mul_i32 s64, s63, 640
    s_cmp_lt_i32 s63, 0
    s_cselect_b32 s64, 1073741824, s64
    buffer_load_dword v122, v7, s[36:39], s64 offen sc1
    s_sub_u32 s63, s56, 8
    s_mul_i32 s64, s63, 640
    s_cmp_lt_i32 s63, 0
    s_cselect_b32 s64, 1073741824, s64
    buffer_load_dword v123, v7, s[36:39], s64 offen sc1
    s_sub_u32 s63, s56, 7
    s_mul_i32 s64, s63, 640
    s_cmp_lt_i32 s63, 0
    s_cselect_b32 s64, 1073741824, s64
    buffer_load_dword v124, v7, s[36:39], s64 offen sc1
    s_sub_u32 s63, s56, 6
    s_mul_i32 s64, s63, 640
    s_cmp_lt_i32 s63, 0
    s_cselect_b32 s64, 1073741824, s64
    buffer_load_dword v125, v7, s[36:39], s64 offen sc1
    s_sub_u32 s63, s56, 5
    s_mul_i32 s64, s63, 640
    s_cmp_lt_i32 s63, 0
    s_cselect_b32 s64, 1073741824, s64
    buffer_load_dword v126, v7, s[36:39], s64 offen sc1
    s_sub_u32 s63, s56, 4
    s_mul_i32 s64, s63, 640
    s_cmp_lt_i32 s63, 0
    s_cselect_b32 s64, 1073741824, s64
    buffer_load_dword v127, v7, s[36:39], s64 offen sc1
    s_sub_u32 s63, s56, 3
    s_mul_i32 s64, s63, 640
    s_cmp_lt_i32 s63, 0
    s_cselect_b32 s64, 1073741824, s64
    buffer_load_dword v128, v7, s[36:39], s64 offen sc1
    s_sub_u32 s63, s56, 2
    s_mul_i32 s64, s63, 640
    s_cmp_lt_i32 s63, 0
    s_cselect_b32 s64, 1073741824, s64
    buffer_load_dword v129, v7, s[36:39], s64 offen sc1
    s_sub_u32 s63, s56, 1
    s_mul_i32 s64, s63, 640
    s_cmp_lt_i32 s63, 0
    s_cselect_b32 s64, 1073741824, s64
    buffer_load_dword v130, v7, s[36:39], s64 offen sc1
    v_mov_b32 v150, 0
    s_add_u32 s69, s69, 1
    s_waitcnt vmcnt(0)
    s_cmp_ge_u32 s56, 15
    s_cselect_b32 s62, 0xfff, 0
    v_xor_b32 v151, s60, v116
    v_and_or_b32 v150, v151, s62, v150
    s_cmp_ge_u32 s56, 14
    s_cselect_b32 s62, 0xfff, 0
    v_xor_b32 v151, s60, v117
    v_and_or_b32 v150, v151, s62, v150
    s_cmp_ge_u32 s56, 13
    s_cselect_b32 s62, 0xfff, 0
    v_xor_b32 v151, s60, v118
    v_and_or_b32 v150, v151, s62, v150
    s_cmp_ge_u32 s56, 12
    s_cselect_b32 s62, 0xfff, 0
    v_xor_b32 v151, s60, v119
    v_and_or_b32 v150, v151, s62, v150
    s_cmp_ge_u32 s56, 11
    s_cselect_b32 s62, 0xfff, 0
    v_xor_b32 v151, s60, v120
    v_and_or_b32 v150, v151, s62, v150
    s_cmp_ge_u32 s56, 10
    s_cselect_b32 s62, 0xfff, 0
    v_xor_b32 v151, s60, v121
    v_and_or_b32 v150, v151, s62, v150
    s_cmp_ge_u32 s56, 9
    s_cselect_b32 s62, 0xfff, 0
    v_xor_b32 v151, s60, v122
    v_and_or_b32 v150, v151, s62, v150
    s_cmp_ge_u32 s56, 8
    s_cselect_b32 s62, 0xfff, 0
    v_xor_b32 v151, s60, v123
    v_and_or_b32 v150, v151, s62, v150
    s_cmp_ge_u32 s56, 7
    s_cselect_b32 s62, 0xfff, 0
    v_xor_b32 v151, s60, v124
    v_and_or_b32 v150, v151, s62, v150
    s_cmp_ge_u32 s56, 6
    s_cselect_b32 s62, 0xfff, 0
    v_xor_b32 v151, s60, v125
    v_and_or_b32 v150, v151, s62, v150
    s_cmp_ge_u32 s56, 5
    s_cselect_b32 s62, 0xfff, 0
    v_xor_b32 v151, s60, v126
    v_and_or_b32 v150, v151, s62, v150
    s_cmp_ge_u32 s56, 4
    s_cselect_b32 s62, 0xfff, 0
    v_xor_b32 v151, s60, v127
    v_and_or_b32 v150, v151, s62, v150
    s_cmp_ge_u32 s56, 3
    s_cselect_b32 s62, 0xfff, 0
    v_xor_b32 v151, s60, v128
    v_and_or_b32 v150, v151, s62, v150
    s_cmp_ge_u32 s56, 2
    s_cselect_b32 s62, 0xfff, 0
    v_xor_b32 v151, s60, v129
    v_and_or_b32 v150, v151, s62, v150
    s_cmp_ge_u32 s56, 1
    s_cselect_b32 s62, 0xfff, 0
    v_xor_b32 v151, s60, v130
    v_and_or_b32 v150, v151, s62, v150
    v_cmp_ne_u32 vcc, 0, v150
    s_cmp_ge_u32 s69, 0x40000
    s_cbranch_scc1 LB_agok
    s_cmp_lg_u64 vcc, 0
    s_cbranch_scc1 LB_ag
LB_agok:
    v_fma_f32 v149, v114, v116, v117
    s_nop 1
    v_fmac_f32_dpp v149, v116, v115 row_ror:8 row_mask:0xf bank_mask:0xf
    v_fma_f32 v148, v114, v149, v118
    s_nop 1
    v_fmac_f32_dpp v148, v149, v115 row_ror:8 row_mask:0xf bank_mask:0xf
    v_fma_f32 v149, v114, v148, v119
    s_nop 1
    v_fmac_f32_dpp v149, v148, v115 row_ror:8 row_mask:0xf bank_mask:0xf
    v_fma_f32 v148, v114, v149, v120
    s_nop 1
    v_fmac_f32_dpp v148, v149, v115 row_ror:8 row_mask:0xf bank_mask:0xf
    v_fma_f32 v149, v114, v148, v121
    s_nop 1
    v_fmac_f32_dpp v149, v148, v115 row_ror:8 row_mask:0xf bank_mask:0xf
    v_fma_f32 v148, v114, v149, v122
    s_nop 1
    v_fmac_f32_dpp v148, v149, v115 row_ror:8 row_mask:0xf bank_mask:0xf
    v_fma_f32 v149, v114, v148, v123
    s_nop 1
    v_fmac_f32_dpp v149, v148, v115 row_ror:8 row_mask:0xf bank_mask:0xf
    v_fma_f32 v148, v114, v149, v124
    s_nop 1
    v_fmac_f32_dpp v148, v149, v115 row_ror:8 row_mask:0xf bank_mask:0xf
    v_fma_f32 v149, v114, v148, v125
    s_nop 1
    v_fmac_f32_dpp v149, v148, v115 row_ror:8 row_mask:0xf bank_mask:0xf
    v_fma_f32 v148, v114, v149, v126
    s_nop 1
    v_fmac_f32_dpp v148, v149, v115 row_ror:8 row_mask:0xf bank_mask:0xf
    v_fma_f32 v149, v114, v148, v127
    s_nop 1
    v_fmac_f32_dpp v149, v148, v115 row_ror:8 row_mask:0xf bank_mask:0xf
    v_fma_f32 v148, v114, v149, v128
    s_nop 1
    v_fmac_f32_dpp v148, v149, v115 row_ror:8 row_mask:0xf bank_mask:0xf
    v_fma_f32 v149, v114, v148, v129
    s_nop 1
    v_fmac_f32_dpp v149, v148, v115 row_ror:8 row_mask:0xf bank_mask:0xf
    v_fma_f32 v132, v114, v149, v130
    s_nop 1
    v_fmac_f32_dpp v132, v149, v115 row_ror:8 row_mask:0xf bank_mask:0xf
    v_fma_f32 v133, v112, v132, v96
    s_nop 1
    v_fmac_f32_dpp v133, v132, v113 row_ror:8 row_mask:0xf bank_mask:0xf
    v_fma_f32 v134, v112, v133, v97
    s_nop 1
    v_fmac_f32_dpp v134, v133, v113 row_ror:8 row_mask:0xf bank_mask:0xf
    v_fma_f32 v135, v112, v134, v98
    s_nop 1
    v_fmac_f32_dpp v135, v134, v113 row_ror:8 row_mask:0xf bank_mask:0xf
    v_fma_f32 v136, v112, v135, v99
    s_nop 1
    v_fmac_f32_dpp v136, v135, v113 row_ror:8 row_mask:0xf bank_mask:0xf
    v_fma_f32 v137, v112, v136, v100
    s_nop 1
    v_fmac_f32_dpp v137, v136, v113 row_ror:8 row_mask:0xf bank_mask:0xf
    v_fma_f32 v138, v112, v137, v101
    s_nop 1
    v_fmac_f32_dpp v138, v137, v113 row_ror:8 row_mask:0xf bank_mask:0xf
    v_fma_f32 v139, v112, v138, v102
    s_nop 1
    v_fmac_f32_dpp v139, v138, v113 row_ror:8 row_mask:0xf bank_mask:0xf
    v_fma_f32 v140, v112, v139, v103
    s_nop 1
    v_fmac_f32_dpp v140, v139, v113 row_ror:8 row_mask:0xf bank_mask:0xf
    v_fma_f32 v141, v112, v140, v104
    s_nop 1
    v_fmac_f32_dpp v141, v140, v113 row_ror:8 row_mask:0xf bank_mask:0xf
    v_fma_f32 v142, v112, v141, v105
    s_nop 1
    v_fmac_f32_dpp v142, v141, v113 row_ror:8 row_mask:0xf bank_mask:0xf
    v_fma_f32 v143, v112, v142, v106
    s_nop 1
    v_fmac_f32_dpp v143, v142, v113 row_ror:8 row_mask:0xf bank_mask:0xf
    v_fma_f32 v144, v112, v143, v107
    s_nop 1
    v_fmac_f32_dpp v144, v143, v113 row_ror:8 row_mask:0xf bank_mask:0xf
    v_fma_f32 v145, v112, v144, v108
    s_nop 1
    v_fmac_f32_dpp v145, v144, v113 row_ror:8 row_mask:0xf bank_mask:0xf
    v_fma_f32 v146, v112, v145, v109
    s_nop 1
    v_fmac_f32_dpp v146, v145, v113 row_ror:8 row_mask:0xf bank_mask:0xf
    v_fma_f32 v147, v112, v146, v110
    s_nop 1
    v_fmac_f32_dpp v147, v146, v113 row_ror:8 row_mask:0xf bank_mask:0xf
    ds_write_b128 v6, v[132:135] offset:0
    ds_write_b128 v6, v[136:139] offset:16
    ds_write_b128 v6, v[140:143] offset:32
    ds_write_b128 v6, v[144:147] offset:48
    s_waitcnt lgkmcnt(0)
    s_barrier
    ds_read_b32 v96, v4 offset:0
    ds_read_b32 v97, v4 offset:1280
    ds_read_b32 v98, v4 offset:2560
    ds_read_b32 v99, v4 offset:3840
    ds_read_b32 v100, v4 offset:5120
    ds_read_b32 v101, v4 offset:6400
    ds_read_b32 v102, v4 offset:7680
    ds_read_b32 v103, v4 offset:8960
    ds_read_b32 v104, v4 offset:10240
    ds_read_b32 v105, v4 offset:11520
    s_waitcnt lgkmcnt(0)
    v_fma_f32 v16, v192, v96, v16
    v_fma_f32 v24, v196, v97, v24
    v_fma_f32 v32, v200, v98, v32
    v_fma_f32 v40, v204, v99, v40
    v_fma_f32 v48, v208, v100, v48
    v_fma_f32 v56, v212, v101, v56
    v_fma_f32 v64, v216, v102, v64
    v_fma_f32 v72, v220, v103, v72
    v_fma_f32 v80, v224, v104, v80
    v_fma_f32 v88, v228, v105, v88
    v_fmac_f32_dpp v16, v96, v193 row_ror:8 row_mask:0xf bank_mask:0xf
    v_fmac_f32_dpp v24, v97, v197 row_ror:8 row_mask:0xf bank_mask:0xf
    v_fmac_f32_dpp v32, v98, v201 row_ror:8 row_mask:0xf bank_mask:0xf
    v_fmac_f32_dpp v40, v99, v205 row_ror:8 row_mask:0xf bank_mask:0xf
    v_fmac_f32_dpp v48, v100, v209 row_ror:8 row_mask:0xf bank_mask:0xf
    v_fmac_f32_dpp v56, v101, v213 row_ror:8 row_mask:0xf bank_mask:0xf
    v_fmac_f32_dpp v64, v102, v217 row_ror:8 row_mask:0xf bank_mask:0xf
    v_fmac_f32_dpp v72, v103, v221 row_ror:8 row_mask:0xf bank_mask:0xf
    v_fmac_f32_dpp v80, v104, v225 row_ror:8 row_mask:0xf bank_mask:0xf
    v_fmac_f32_dpp v88, v105, v229 row_ror:8 row_mask:0xf bank_mask:0xf
    v_fma_f32 v17, v192, v16, v17
    v_fma_f32 v25, v196, v24, v25
    v_fma_f32 v33, v200, v32, v33
    v_fma_f32 v41, v204, v40, v41
    v_fma_f32 v49, v208, v48, v49
    v_fma_f32 v57, v212, v56, v57
    v_fma_f32 v65, v216, v64, v65
    v_fma_f32 v73, v220, v72, v73
    v_fma_f32 v81, v224, v80, v81
    v_fma_f32 v89, v228, v88, v89
    v_fmac_f32_dpp v17, v16, v193 row_ror:8 row_mask:0xf bank_mask:0xf
    v_fmac_f32_dpp v25, v24, v197 row_ror:8 row_mask:0xf bank_mask:0xf
    v_fmac_f32_dpp v33, v32, v201 row_ror:8 row_mask:0xf bank_mask:0xf
    v_fmac_f32_dpp v41, v40, v205 row_ror:8 row_mask:0xf bank_mask:0xf
    v_fmac_f32_dpp v49, v48, v209 row_ror:8 row_mask:0xf bank_mask:0xf
    v_fmac_f32_dpp v57, v56, v213 row_ror:8 row_mask:0xf bank_mask:0xf
    v_fmac_f32_dpp v65, v64, v217 row_ror:8 row_mask:0xf bank_mask:0xf
    v_fmac_f32_dpp v73, v72, v221 row_ror:8 row_mask:0xf bank_mask:0xf
    v_fmac_f32_dpp v81, v80, v225 row_ror:8 row_mask:0xf bank_mask:0xf
    v_fmac_f32_dpp v89, v88, v229 row_ror:8 row_mask:0xf bank_mask:0xf
    v_fma_f32 v18, v192, v17, v18
    v_fma_f32 v26, v196, v25, v26
    v_fma_f32 v34, v200, v33, v34
    v_fma_f32 v42, v204, v41, v42
    v_fma_f32 v50, v208, v49, v50
    v_fma_f32 v58, v212, v57, v58
    v_fma_f32 v66, v216, v65, v66
    v_fma_f32 v74, v220, v73, v74
    v_fma_f32 v82, v224, v81, v82
    v_fma_f32 v90, v228, v89, v90
    v_fmac_f32_dpp v18, v17, v193 row_ror:8 row_mask:0xf bank_mask:0xf
    v_fmac_f32_dpp v26, v25, v197 row_ror:8 row_mask:0xf bank_mask:0xf
    v_fmac_f32_dpp v34, v33, v201 row_ror:8 row_mask:0xf bank_mask:0xf
    v_fmac_f32_dpp v42, v41, v205 row_ror:8 row_mask:0xf bank_mask:0xf
    v_fmac_f32_dpp v50, v49, v209 row_ror:8 row_mask:0xf bank_mask:0xf
    v_fmac_f32_dpp v58, v57, v213 row_ror:8 row_mask:0xf bank_mask:0xf
    v_fmac_f32_dpp v66, v65, v217 row_ror:8 row_mask:0xf bank_mask:0xf
    v_fmac_f32_dpp v74, v73, v221 row_ror:8 row_mask:0xf bank_mask:0xf
    v_fmac_f32_dpp v82, v81, v225 row_ror:8 row_mask:0xf bank_mask:0xf
    v_fmac_f32_dpp v90, v89, v229 row_ror:8 row_mask:0xf bank_mask:0xf
    v_fma_f32 v19, v192, v18, v19
    v_fma_f32 v27, v196, v26, v27
    v_fma_f32 v35, v200, v34, v35
    v_fma_f32 v43, v204, v42, v43
    v_fma_f32 v51, v208, v50, v51
    v_fma_f32 v59, v212, v58, v59
    v_fma_f32 v67, v216, v66, v67
    v_fma_f32 v75, v220, v74, v75
    v_fma_f32 v83, v224, v82, v83
    v_fma_f32 v91, v228, v90, v91
    v_fmac_f32_dpp v19, v18, v193 row_ror:8 row_mask:0xf bank_mask:0xf
    v_fmac_f32_dpp v27, v26, v197 row_ror:8 row_mask:0xf bank_mask:0xf
    v_fmac_f32_dpp v35, v34, v201 row_ror:8 row_mask:0xf bank_mask:0xf
    v_fmac_f32_dpp v43, v42, v205 row_ror:8 row_mask:0xf bank_mask:0xf
    v_fmac_f32_dpp v51, v50, v209 row_ror:8 row_mask:0xf bank_mask:0xf
    v_fmac_f32_dpp v59, v58, v213 row_ror:8 row_mask:0xf bank_mask:0xf
    v_fmac_f32_dpp v67, v66, v217 row_ror:8 row_mask:0xf bank_mask:0xf
    v_fmac_f32_dpp v75, v74, v221 row_ror:8 row_mask:0xf bank_mask:0xf
    v_fmac_f32_dpp v83, v82, v225 row_ror:8 row_mask:0xf bank_mask:0xf
    v_fmac_f32_dpp v91, v90, v229 row_ror:8 row_mask:0xf bank_mask:0xf
    v_fma_f32 v20, v192, v19, v20
    v_fma_f32 v28, v196, v27, v28
    v_fma_f32 v36, v200, v35, v36
    v_fma_f32 v44, v204, v43, v44
    v_fma_f32 v52, v208, v51, v52
    v_fma_f32 v60, v212, v59, v60
    v_fma_f32 v68, v216, v67, v68
    v_fma_f32 v76, v220, v75, v76
    v_fma_f32 v84, v224, v83, v84
    v_fma_f32 v92, v228, v91, v92
    v_fmac_f32_dpp v20, v19, v193 row_ror:8 row_mask:0xf bank_mask:0xf
    v_fmac_f32_dpp v28, v27, v197 row_ror:8 row_mask:0xf bank_mask:0xf
    v_fmac_f32_dpp v36, v35, v201 row_ror:8 row_mask:0xf bank_mask:0xf
    v_fmac_f32_dpp v44, v43, v205 row_ror:8 row_mask:0xf bank_mask:0xf
    v_fmac_f32_dpp v52, v51, v209 row_ror:8 row_mask:0xf bank_mask:0xf
    v_fmac_f32_dpp v60, v59, v213 row_ror:8 row_mask:0xf bank_mask:0xf
    v_fmac_f32_dpp v68, v67, v217 row_ror:8 row_mask:0xf bank_mask:0xf
    v_fmac_f32_dpp v76, v75, v221 row_ror:8 row_mask:0xf bank_mask:0xf
    v_fmac_f32_dpp v84, v83, v225 row_ror:8 row_mask:0xf bank_mask:0xf
    v_fmac_f32_dpp v92, v91, v229 row_ror:8 row_mask:0xf bank_mask:0xf
    v_fma_f32 v21, v192, v20, v21
    v_fma_f32 v29, v196, v28, v29
    v_fma_f32 v37, v200, v36, v37
    v_fma_f32 v45, v204, v44, v45
    v_fma_f32 v53, v208, v52, v53
    v_fma_f32 v61, v212, v60, v61
    v_fma_f32 v69, v216, v68, v69
    v_fma_f32 v77, v220, v76, v77
    v_fma_f32 v85, v224, v84, v85
    v_fma_f32 v93, v228, v92, v93
    v_fmac_f32_dpp v21, v20, v193 row_ror:8 row_mask:0xf bank_mask:0xf
    v_fmac_f32_dpp v29, v28, v197 row_ror:8 row_mask:0xf bank_mask:0xf
    v_fmac_f32_dpp v37, v36, v201 row_ror:8 row_mask:0xf bank_mask:0xf
    v_fmac_f32_dpp v45, v44, v205 row_ror:8 row_mask:0xf bank_mask:0xf
    v_fmac_f32_dpp v53, v52, v209 row_ror:8 row_mask:0xf bank_mask:0xf
    v_fmac_f32_dpp v61, v60, v213 row_ror:8 row_mask:0xf bank_mask:0xf
    v_fmac_f32_dpp v69, v68, v217 row_ror:8 row_mask:0xf bank_mask:0xf
    v_fmac_f32_dpp v77, v76, v221 row_ror:8 row_mask:0xf bank_mask:0xf
    v_fmac_f32_dpp v85, v84, v225 row_ror:8 row_mask:0xf bank_mask:0xf
    v_fmac_f32_dpp v93, v92, v229 row_ror:8 row_mask:0xf bank_mask:0xf
    v_fma_f32 v22, v192, v21, v22
    v_fma_f32 v30, v196, v29, v30
    v_fma_f32 v38, v200, v37, v38
    v_fma_f32 v46, v204, v45, v46
    v_fma_f32 v54, v208, v53, v54
    v_fma_f32 v62, v212, v61, v62
    v_fma_f32 v70, v216, v69, v70
    v_fma_f32 v78, v220, v77, v78
    v_fma_f32 v86, v224, v85, v86
    v_fma_f32 v94, v228, v93, v94
    v_fmac_f32_dpp v22, v21, v193 row_ror:8 row_mask:0xf bank_mask:0xf
    v_fmac_f32_dpp v30, v29, v197 row_ror:8 row_mask:0xf bank_mask:0xf
    v_fmac_f32_dpp v38, v37, v201 row_ror:8 row_mask:0xf bank_mask:0xf
    v_fmac_f32_dpp v46, v45, v205 row_ror:8 row_mask:0xf bank_mask:0xf
    v_fmac_f32_dpp v54, v53, v209 row_ror:8 row_mask:0xf bank_mask:0xf
    v_fmac_f32_dpp v62, v61, v213 row_ror:8 row_mask:0xf bank_mask:0xf
    v_fmac_f32_dpp v70, v69, v217 row_ror:8 row_mask:0xf bank_mask:0xf
    v_fmac_f32_dpp v78, v77, v221 row_ror:8 row_mask:0xf bank_mask:0xf
    v_fmac_f32_dpp v86, v85, v225 row_ror:8 row_mask:0xf bank_mask:0xf
    v_fmac_f32_dpp v94, v93, v229 row_ror:8 row_mask:0xf bank_mask:0xf
    v_fma_f32 v23, v192, v22, v23
    v_fma_f32 v31, v196, v30, v31
    v_fma_f32 v39, v200, v38, v39
    v_fma_f32 v47, v204, v46, v47
    v_fma_f32 v55, v208, v54, v55
    v_fma_f32 v63, v212, v62, v63
    v_fma_f32 v71, v216, v70, v71
    v_fma_f32 v79, v220, v78, v79
    v_fma_f32 v87, v224, v86, v87
    v_fma_f32 v95, v228, v94, v95
    v_fmac_f32_dpp v23, v22, v193 row_ror:8 row_mask:0xf bank_mask:0xf
    v_fmac_f32_dpp v31, v30, v197 row_ror:8 row_mask:0xf bank_mask:0xf
    v_fmac_f32_dpp v39, v38, v201 row_ror:8 row_mask:0xf bank_mask:0xf
    v_fmac_f32_dpp v47, v46, v205 row_ror:8 row_mask:0xf bank_mask:0xf
    v_fmac_f32_dpp v55, v54, v209 row_ror:8 row_mask:0xf bank_mask:0xf
    v_fmac_f32_dpp v63, v62, v213 row_ror:8 row_mask:0xf bank_mask:0xf
    v_fmac_f32_dpp v71, v70, v217 row_ror:8 row_mask:0xf bank_mask:0xf
    v_fmac_f32_dpp v79, v78, v221 row_ror:8 row_mask:0xf bank_mask:0xf
    v_fmac_f32_dpp v87, v86, v225 row_ror:8 row_mask:0xf bank_mask:0xf
    v_fmac_f32_dpp v95, v94, v229 row_ror:8 row_mask:0xf bank_mask:0xf
    v_mul_f32 v108, v194, v16
    v_mul_f32 v109, v194, v17
    v_mul_f32 v110, v194, v18
    v_mul_f32 v111, v194, v19
    v_mul_f32 v112, v194, v20
    v_mul_f32 v113, v194, v21
    v_mul_f32 v114, v194, v22
    v_mul_f32 v115, v194, v23
    v_fmac_f32_dpp v108, v16, v195 row_ror:8 row_mask:0xf bank_mask:0xf
    v_fmac_f32_dpp v109, v17, v195 row_ror:8 row_mask:0xf bank_mask:0xf
    v_fmac_f32_dpp v110, v18, v195 row_ror:8 row_mask:0xf bank_mask:0xf
    v_fmac_f32_dpp v111, v19, v195 row_ror:8 row_mask:0xf bank_mask:0xf
    v_fmac_f32_dpp v112, v20, v195 row_ror:8 row_mask:0xf bank_mask:0xf
    v_fmac_f32_dpp v113, v21, v195 row_ror:8 row_mask:0xf bank_mask:0xf
    v_fmac_f32_dpp v114, v22, v195 row_ror:8 row_mask:0xf bank_mask:0xf
    v_fmac_f32_dpp v115, v23, v195 row_ror:8 row_mask:0xf bank_mask:0xf
    v_cvt_pk_bf16_f32 v124, v108, v109
    v_cvt_pk_bf16_f32 v125, v110, v111
    v_cvt_pk_bf16_f32 v126, v112, v113
    v_cvt_pk_bf16_f32 v127, v114, v115
    ds_write_b128 v247, v[124:127] offset:0
    ds_read_b64_tr_b16 v[132:133], v248 offset:0
    ds_read_b64_tr_b16 v[134:135], v248 offset:256
    v_mul_f32 v116, v198, v24
    v_mul_f32 v117, v198, v25
    v_mul_f32 v118, v198, v26
    v_mul_f32 v119, v198, v27
    v_mul_f32 v120, v198, v28
    v_mul_f32 v121, v198, v29
    v_mul_f32 v122, v198, v30
    v_mul_f32 v123, v198, v31
    v_fmac_f32_dpp v116, v24, v199 row_ror:8 row_mask:0xf bank_mask:0xf
    v_fmac_f32_dpp v117, v25, v199 row_ror:8 row_mask:0xf bank_mask:0xf
    v_fmac_f32_dpp v118, v26, v199 row_ror:8 row_mask:0xf bank_mask:0xf
    v_fmac_f32_dpp v119, v27, v199 row_ror:8 row_mask:0xf bank_mask:0xf
    v_fmac_f32_dpp v120, v28, v199 row_ror:8 row_mask:0xf bank_mask:0xf
    v_fmac_f32_dpp v121, v29, v199 row_ror:8 row_mask:0xf bank_mask:0xf
    v_fmac_f32_dpp v122, v30, v199 row_ror:8 row_mask:0xf bank_mask:0xf
    v_fmac_f32_dpp v123, v31, v199 row_ror:8 row_mask:0xf bank_mask:0xf
    s_movk_i32 s62, 0
    s_waitcnt lgkmcnt(0)
    buffer_store_dwordx4 v[132:135], v249, s[36:39], s62 offen offset:0 sc1
    v_cvt_pk_bf16_f32 v128, v116, v117
    v_cvt_pk_bf16_f32 v129, v118, v119
    v_cvt_pk_bf16_f32 v130, v120, v121
    v_cvt_pk_bf16_f32 v131, v122, v123
    ds_write_b128 v247, v[128:131] offset:1024
    ds_read_b64_tr_b16 v[136:137], v248 offset:1024
    ds_read_b64_tr_b16 v[138:139], v248 offset:1280
    v_mul_f32 v108, v202, v32
    v_mul_f32 v109, v202, v33
    v_mul_f32 v110, v202, v34
    v_mul_f32 v111, v202, v35
    v_mul_f32 v112, v202, v36
    v_mul_f32 v113, v202, v37
    v_mul_f32 v114, v202, v38
    v_mul_f32 v115, v202, v39
    v_fmac_f32_dpp v108, v32, v203 row_ror:8 row_mask:0xf bank_mask:0xf
    v_fmac_f32_dpp v109, v33, v203 row_ror:8 row_mask:0xf bank_mask:0xf
    v_fmac_f32_dpp v110, v34, v203 row_ror:8 row_mask:0xf bank_mask:0xf
    v_fmac_f32_dpp v111, v35, v203 row_ror:8 row_mask:0xf bank_mask:0xf
    v_fmac_f32_dpp v112, v36, v203 row_ror:8 row_mask:0xf bank_mask:0xf
    v_fmac_f32_dpp v113, v37, v203 row_ror:8 row_mask:0xf bank_mask:0xf
    v_fmac_f32_dpp v114, v38, v203 row_ror:8 row_mask:0xf bank_mask:0xf
    v_fmac_f32_dpp v115, v39, v203 row_ror:8 row_mask:0xf bank_mask:0xf
    s_movk_i32 s62, 0
    s_waitcnt lgkmcnt(0)
    buffer_store_dwordx4 v[136:139], v249, s[36:39], s62 offen offset:1024 sc1
    v_cvt_pk_bf16_f32 v124, v108, v109
    v_cvt_pk_bf16_f32 v125, v110, v111
    v_cvt_pk_bf16_f32 v126, v112, v113
    v_cvt_pk_bf16_f32 v127, v114, v115
    ds_write_b128 v247, v[124:127] offset:0
    ds_read_b64_tr_b16 v[132:133], v248 offset:0
    ds_read_b64_tr_b16 v[134:135], v248 offset:256
    v_mul_f32 v116, v206, v40
    v_mul_f32 v117, v206, v41
    v_mul_f32 v118, v206, v42
    v_mul_f32 v119, v206, v43
    v_mul_f32 v120, v206, v44
    v_mul_f32 v121, v206, v45
    v_mul_f32 v122, v206, v46
    v_mul_f32 v123, v206, v47
    v_fmac_f32_dpp v116, v40, v207 row_ror:8 row_mask:0xf bank_mask:0xf
    v_fmac_f32_dpp v117, v41, v207 row_ror:8 row_mask:0xf bank_mask:0xf
    v_fmac_f32_dpp v118, v42, v207 row_ror:8 row_mask:0xf bank_mask:0xf
    v_fmac_f32_dpp v119, v43, v207 row_ror:8 row_mask:0xf bank_mask:0xf
    v_fmac_f32_dpp v120, v44, v207 row_ror:8 row_mask:0xf bank_mask:0xf
    v_fmac_f32_dpp v121, v45, v207 row_ror:8 row_mask:0xf bank_mask:0xf
    v_fmac_f32_dpp v122, v46, v207 row_ror:8 row_mask:0xf bank_mask:0xf
    v_fmac_f32_dpp v123, v47, v207 row_ror:8 row_mask:0xf bank_mask:0xf
    s_movk_i32 s62, 0
    s_waitcnt lgkmcnt(0)
    buffer_store_dwordx4 v[132:135], v249, s[36:39], s62 offen offset:2048 sc1
    v_cvt_pk_bf16_f32 v128, v116, v117
    v_cvt_pk_bf16_f32 v129, v118, v119
    v_cvt_pk_bf16_f32 v130, v120, v121
    v_cvt_pk_bf16_f32 v131, v122, v123
    ds_write_b128 v247, v[128:131] offset:1024
    ds_read_b64_tr_b16 v[136:137], v248 offset:1024
    ds_read_b64_tr_b16 v[138:139], v248 offset:1280
    v_mul_f32 v108, v210, v48
    v_mul_f32 v109, v210, v49
    v_mul_f32 v110, v210, v50
    v_mul_f32 v111, v210, v51
    v_mul_f32 v112, v210, v52
    v_mul_f32 v113, v210, v53
    v_mul_f32 v114, v210, v54
    v_mul_f32 v115, v210, v55
    v_fmac_f32_dpp v108, v48, v211 row_ror:8 row_mask:0xf bank_mask:0xf
    v_fmac_f32_dpp v109, v49, v211 row_ror:8 row_mask:0xf bank_mask:0xf
    v_fmac_f32_dpp v110, v50, v211 row_ror:8 row_mask:0xf bank_mask:0xf
    v_fmac_f32_dpp v111, v51, v211 row_ror:8 row_mask:0xf bank_mask:0xf
    v_fmac_f32_dpp v112, v52, v211 row_ror:8 row_mask:0xf bank_mask:0xf
    v_fmac_f32_dpp v113, v53, v211 row_ror:8 row_mask:0xf bank_mask:0xf
    v_fmac_f32_dpp v114, v54, v211 row_ror:8 row_mask:0xf bank_mask:0xf
    v_fmac_f32_dpp v115, v55, v211 row_ror:8 row_mask:0xf bank_mask:0xf
    s_movk_i32 s62, 0
    s_waitcnt lgkmcnt(0)
    buffer_store_dwordx4 v[136:139], v249, s[36:39], s62 offen offset:3072 sc1
    v_cvt_pk_bf16_f32 v124, v108, v109
    v_cvt_pk_bf16_f32 v125, v110, v111
    v_cvt_pk_bf16_f32 v126, v112, v113
    v_cvt_pk_bf16_f32 v127, v114, v115
    ds_write_b128 v247, v[124:127] offset:0
    ds_read_b64_tr_b16 v[132:133], v248 offset:0
    ds_read_b64_tr_b16 v[134:135], v248 offset:256
    v_mul_f32 v116, v214, v56
    v_mul_f32 v117, v214, v57
    v_mul_f32 v118, v214, v58
    v_mul_f32 v119, v214, v59
    v_mul_f32 v120, v214, v60
    v_mul_f32 v121, v214, v61
    v_mul_f32 v122, v214, v62
    v_mul_f32 v123, v214, v63
    v_fmac_f32_dpp v116, v56, v215 row_ror:8 row_mask:0xf bank_mask:0xf
    v_fmac_f32_dpp v117, v57, v215 row_ror:8 row_mask:0xf bank_mask:0xf
    v_fmac_f32_dpp v118, v58, v215 row_ror:8 row_mask:0xf bank_mask:0xf
    v_fmac_f32_dpp v119, v59, v215 row_ror:8 row_mask:0xf bank_mask:0xf
    v_fmac_f32_dpp v120, v60, v215 row_ror:8 row_mask:0xf bank_mask:0xf
    v_fmac_f32_dpp v121, v61, v215 row_ror:8 row_mask:0xf bank_mask:0xf
    v_fmac_f32_dpp v122, v62, v215 row_ror:8 row_mask:0xf bank_mask:0xf
    v_fmac_f32_dpp v123, v63, v215 row_ror:8 row_mask:0xf bank_mask:0xf
    s_movk_i32 s62, 4096
    s_waitcnt lgkmcnt(0)
    buffer_store_dwordx4 v[132:135], v249, s[36:39], s62 offen offset:0 sc1
    v_cvt_pk_bf16_f32 v128, v116, v117
    v_cvt_pk_bf16_f32 v129, v118, v119
    v_cvt_pk_bf16_f32 v130, v120, v121
    v_cvt_pk_bf16_f32 v131, v122, v123
    ds_write_b128 v247, v[128:131] offset:1024
    ds_read_b64_tr_b16 v[136:137], v248 offset:1024
    ds_read_b64_tr_b16 v[138:139], v248 offset:1280
    v_mul_f32 v108, v218, v64
    v_mul_f32 v109, v218, v65
    v_mul_f32 v110, v218, v66
    v_mul_f32 v111, v218, v67
    v_mul_f32 v112, v218, v68
    v_mul_f32 v113, v218, v69
    v_mul_f32 v114, v218, v70
    v_mul_f32 v115, v218, v71
    v_fmac_f32_dpp v108, v64, v219 row_ror:8 row_mask:0xf bank_mask:0xf
    v_fmac_f32_dpp v109, v65, v219 row_ror:8 row_mask:0xf bank_mask:0xf
    v_fmac_f32_dpp v110, v66, v219 row_ror:8 row_mask:0xf bank_mask:0xf
    v_fmac_f32_dpp v111, v67, v219 row_ror:8 row_mask:0xf bank_mask:0xf
    v_fmac_f32_dpp v112, v68, v219 row_ror:8 row_mask:0xf bank_mask:0xf
    v_fmac_f32_dpp v113, v69, v219 row_ror:8 row_mask:0xf bank_mask:0xf
    v_fmac_f32_dpp v114, v70, v219 row_ror:8 row_mask:0xf bank_mask:0xf
    v_fmac_f32_dpp v115, v71, v219 row_ror:8 row_mask:0xf bank_mask:0xf
    s_movk_i32 s62, 4096
    s_waitcnt lgkmcnt(0)
    buffer_store_dwordx4 v[136:139], v249, s[36:39], s62 offen offset:1024 sc1
    v_cvt_pk_bf16_f32 v124, v108, v109
    v_cvt_pk_bf16_f32 v125, v110, v111
    v_cvt_pk_bf16_f32 v126, v112, v113
    v_cvt_pk_bf16_f32 v127, v114, v115
    ds_write_b128 v247, v[124:127] offset:0
    ds_read_b64_tr_b16 v[132:133], v248 offset:0
    ds_read_b64_tr_b16 v[134:135], v248 offset:256
    v_mul_f32 v116, v222, v72
    v_mul_f32 v117, v222, v73
    v_mul_f32 v118, v222, v74
    v_mul_f32 v119, v222, v75
    v_mul_f32 v120, v222, v76
    v_mul_f32 v121, v222, v77
    v_mul_f32 v122, v222, v78
    v_mul_f32 v123, v222, v79
    v_fmac_f32_dpp v116, v72, v223 row_ror:8 row_mask:0xf bank_mask:0xf
    v_fmac_f32_dpp v117, v73, v223 row_ror:8 row_mask:0xf bank_mask:0xf
    v_fmac_f32_dpp v118, v74, v223 row_ror:8 row_mask:0xf bank_mask:0xf
    v_fmac_f32_dpp v119, v75, v223 row_ror:8 row_mask:0xf bank_mask:0xf
    v_fmac_f32_dpp v120, v76, v223 row_ror:8 row_mask:0xf bank_mask:0xf
    v_fmac_f32_dpp v121, v77, v223 row_ror:8 row_mask:0xf bank_mask:0xf
    v_fmac_f32_dpp v122, v78, v223 row_ror:8 row_mask:0xf bank_mask:0xf
    v_fmac_f32_dpp v123, v79, v223 row_ror:8 row_mask:0xf bank_mask:0xf
    s_movk_i32 s62, 4096
    s_waitcnt lgkmcnt(0)
    buffer_store_dwordx4 v[132:135], v249, s[36:39], s62 offen offset:2048 sc1
    v_cvt_pk_bf16_f32 v128, v116, v117
    v_cvt_pk_bf16_f32 v129, v118, v119
    v_cvt_pk_bf16_f32 v130, v120, v121
    v_cvt_pk_bf16_f32 v131, v122, v123
    ds_write_b128 v247, v[128:131] offset:1024
    ds_read_b64_tr_b16 v[136:137], v248 offset:1024
    ds_read_b64_tr_b16 v[138:139], v248 offset:1280
    v_mul_f32 v108, v226, v80
    v_mul_f32 v109, v226, v81
    v_mul_f32 v110, v226, v82
    v_mul_f32 v111, v226, v83
    v_mul_f32 v112, v226, v84
    v_mul_f32 v113, v226, v85
    v_mul_f32 v114, v226, v86
    v_mul_f32 v115, v226, v87
    v_fmac_f32_dpp v108, v80, v227 row_ror:8 row_mask:0xf bank_mask:0xf
    v_fmac_f32_dpp v109, v81, v227 row_ror:8 row_mask:0xf bank_mask:0xf
    v_fmac_f32_dpp v110, v82, v227 row_ror:8 row_mask:0xf bank_mask:0xf
    v_fmac_f32_dpp v111, v83, v227 row_ror:8 row_mask:0xf bank_mask:0xf
    v_fmac_f32_dpp v112, v84, v227 row_ror:8 row_mask:0xf bank_mask:0xf
    v_fmac_f32_dpp v113, v85, v227 row_ror:8 row_mask:0xf bank_mask:0xf
    v_fmac_f32_dpp v114, v86, v227 row_ror:8 row_mask:0xf bank_mask:0xf
    v_fmac_f32_dpp v115, v87, v227 row_ror:8 row_mask:0xf bank_mask:0xf
    s_movk_i32 s62, 4096
    s_waitcnt lgkmcnt(0)
    buffer_store_dwordx4 v[136:139], v249, s[36:39], s62 offen offset:3072 sc1
    v_cvt_pk_bf16_f32 v124, v108, v109
    v_cvt_pk_bf16_f32 v125, v110, v111
    v_cvt_pk_bf16_f32 v126, v112, v113
    v_cvt_pk_bf16_f32 v127, v114, v115
    ds_write_b128 v247, v[124:127] offset:0
    ds_read_b64_tr_b16 v[132:133], v248 offset:0
    ds_read_b64_tr_b16 v[134:135], v248 offset:256
    v_mul_f32 v116, v230, v88
    v_mul_f32 v117, v230, v89
    v_mul_f32 v118, v230, v90
    v_mul_f32 v119, v230, v91
    v_mul_f32 v120, v230, v92
    v_mul_f32 v121, v230, v93
    v_mul_f32 v122, v230, v94
    v_mul_f32 v123, v230, v95
    v_fmac_f32_dpp v116, v88, v231 row_ror:8 row_mask:0xf bank_mask:0xf
    v_fmac_f32_dpp v117, v89, v231 row_ror:8 row_mask:0xf bank_mask:0xf
    v_fmac_f32_dpp v118, v90, v231 row_ror:8 row_mask:0xf bank_mask:0xf
    v_fmac_f32_dpp v119, v91, v231 row_ror:8 row_mask:0xf bank_mask:0xf
    v_fmac_f32_dpp v120, v92, v231 row_ror:8 row_mask:0xf bank_mask:0xf
    v_fmac_f32_dpp v121, v93, v231 row_ror:8 row_mask:0xf bank_mask:0xf
    v_fmac_f32_dpp v122, v94, v231 row_ror:8 row_mask:0xf bank_mask:0xf
    v_fmac_f32_dpp v123, v95, v231 row_ror:8 row_mask:0xf bank_mask:0xf
    s_movk_i32 s62, 8192
    s_waitcnt lgkmcnt(0)
    buffer_store_dwordx4 v[132:135], v249, s[36:39], s62 offen offset:0 sc1
    v_cvt_pk_bf16_f32 v128, v116, v117
    v_cvt_pk_bf16_f32 v129, v118, v119
    v_cvt_pk_bf16_f32 v130, v120, v121
    v_cvt_pk_bf16_f32 v131, v122, v123
    ds_write_b128 v247, v[128:131] offset:1024
    ds_read_b64_tr_b16 v[136:137], v248 offset:1024
    ds_read_b64_tr_b16 v[138:139], v248 offset:1280
    s_movk_i32 s62, 8192
    s_waitcnt lgkmcnt(0)
    buffer_store_dwordx4 v[136:139], v249, s[36:39], s62 offen offset:1024 sc1
    v_mov_b32 v16, 0
    v_mov_b32 v17, 0
    v_mov_b32 v18, 0
    v_mov_b32 v19, 0
    v_mov_b32 v20, 0
    v_mov_b32 v21, 0
    v_mov_b32 v22, 0
    v_mov_b32 v23, 0
    v_mov_b32 v24, 0
    v_mov_b32 v25, 0
    v_mov_b32 v26, 0
    v_mov_b32 v27, 0
    v_mov_b32 v28, 0
    v_mov_b32 v29, 0
    v_mov_b32 v30, 0
    v_mov_b32 v31, 0
    v_mov_b32 v32, 0
    v_mov_b32 v33, 0
    v_mov_b32 v34, 0
    v_mov_b32 v35, 0
    v_mov_b32 v36, 0
    v_mov_b32 v37, 0
    v_mov_b32 v38, 0
    v_mov_b32 v39, 0
    v_mov_b32 v40, 0
    v_mov_b32 v41, 0
    v_mov_b32 v42, 0
    v_mov_b32 v43, 0
    v_mov_b32 v44, 0
    v_mov_b32 v45, 0
    v_mov_b32 v46, 0
    v_mov_b32 v47, 0
    v_mov_b32 v48, 0
    v_mov_b32 v49, 0
    v_mov_b32 v50, 0
    v_mov_b32 v51, 0
    v_mov_b32 v52, 0
    v_mov_b32 v53, 0
    v_mov_b32 v54, 0
    v_mov_b32 v55, 0
    v_mov_b32 v56, 0
    v_mov_b32 v57, 0
    v_mov_b32 v58, 0
    v_mov_b32 v59, 0
    v_mov_b32 v60, 0
    v_mov_b32 v61, 0
    v_mov_b32 v62, 0
    v_mov_b32 v63, 0
    v_mov_b32 v64, 0
    v_mov_b32 v65, 0
    v_mov_b32 v66, 0
    v_mov_b32 v67, 0
    v_mov_b32 v68, 0
    v_mov_b32 v69, 0
    v_mov_b32 v70, 0
    v_mov_b32 v71, 0
    v_mov_b32 v72, 0
    v_mov_b32 v73, 0
    v_mov_b32 v74, 0
    v_mov_b32 v75, 0
    v_mov_b32 v76, 0
    v_mov_b32 v77, 0
    v_mov_b32 v78, 0
    v_mov_b32 v79, 0
    v_mov_b32 v80, 0
    v_mov_b32 v81, 0
    v_mov_b32 v82, 0
    v_mov_b32 v83, 0
    v_mov_b32 v84, 0
    v_mov_b32 v85, 0
    v_mov_b32 v86, 0
    v_mov_b32 v87, 0
    v_mov_b32 v88, 0
    v_mov_b32 v89, 0
    v_mov_b32 v90, 0
    v_mov_b32 v91, 0
    v_mov_b32 v92, 0
    v_mov_b32 v93, 0
    v_mov_b32 v94, 0
    v_mov_b32 v95, 0
    v_mov_b32 v96, 0
    v_mov_b32 v97, 0
    v_mov_b32 v98, 0
    v_mov_b32 v99, 0
    v_mov_b32 v100, 0
    v_mov_b32 v101, 0
    v_mov_b32 v102, 0
    v_mov_b32 v103, 0
    v_mov_b32 v104, 0
    v_mov_b32 v105, 0
    v_mov_b32 v106, 0
    v_mov_b32 v107, 0
    v_mov_b32 v108, 0
    v_mov_b32 v109, 0
    v_mov_b32 v110, 0
    v_mov_b32 v111, 0
    s_waitcnt vmcnt(0)
    v_mov_b32 v2, 0
    v_mov_b32 v3, s60
    s_mov_b64 exec, 1
    buffer_store_dword v3, v2, s[36:39], s80 offen sc1
    s_mov_b64 exec, -1
    s_barrier
    s_cmp_eq_u32 s81, 7
    s_cbranch_scc1 LB_idle
    buffer_load_ushort v8, v246, s[48:51], 0 offen offset:0
    buffer_load_ushort v9, v246, s[48:51], 0 offen offset:64
    buffer_load_ushort v10, v246, s[48:51], 0 offen offset:128
    s_mov_b32 s68, 0
    buffer_load_short_d16_hi v64, v245, s[44:47], s68 offen offset:0
    buffer_load_short_d16_hi v80, v245, s[44:47], s68 offen offset:64
    buffer_load_short_d16_hi v96, v245, s[44:47], s68 offen offset:128
    s_mov_b32 s68, 1280
    buffer_load_short_d16_hi v65, v245, s[44:47], s68 offen offset:0
    buffer_load_short_d16_hi v81, v245, s[44:47], s68 offen offset:64
    buffer_load_short_d16_hi v97, v245, s[44:47], s68 offen offset:128
    s_mov_b32 s68, 2560
    buffer_load_short_d16_hi v66, v245, s[44:47], s68 offen offset:0
    buffer_load_short_d16_hi v82, v245, s[44:47], s68 offen offset:64
    buffer_load_short_d16_hi v98, v245, s[44:47], s68 offen offset:128
    s_mov_b32 s68, 3840
    buffer_load_short_d16_hi v67, v245, s[44:47], s68 offen offset:0
    buffer_load_short_d16_hi v83, v245, s[44:47], s68 offen offset:64
    buffer_load_short_d16_hi v99, v245, s[44:47], s68 offen offset:128
    s_mov_b32 s68, 10240
    buffer_load_short_d16_hi v68, v245, s[44:47], s68 offen offset:0
    buffer_load_short_d16_hi v84, v245, s[44:47], s68 offen offset:64
    buffer_load_short_d16_hi v100, v245, s[44:47], s68 offen offset:128
    s_mov_b32 s68, 11520
    buffer_load_short_d16_hi v69, v245, s[44:47], s68 offen offset:0
    buffer_load_short_d16_hi v85, v245, s[44:47], s68 offen offset:64
    buffer_load_short_d16_hi v101, v245, s[44:47], s68 offen offset:128
    s_mov_b32 s68, 12800
    buffer_load_short_d16_hi v70, v245, s[44:47], s68 offen offset:0
    buffer_load_short_d16_hi v86, v245, s[44:47], s68 offen offset:64
    buffer_load_short_d16_hi v102, v245, s[44:47], s68 offen offset:128
    s_mov_b32 s68, 14080
    buffer_load_short_d16_hi v71, v245, s[44:47], s68 offen offset:0
    buffer_load_short_d16_hi v87, v245, s[44:47], s68 offen offset:64
    buffer_load_short_d16_hi v103, v245, s[44:47], s68 offen offset:128
    s_mov_b32 s68, 20480
    buffer_load_short_d16_hi v72, v245, s[44:47], s68 offen offset:0
    buffer_load_short_d16_hi v88, v245, s[44:47], s68 offen offset:64
    buffer_load_short_d16_hi v104, v245, s[44:47], s68 offen offset:128
    s_mov_b32 s68, 21760
    buffer_load_short_d16_hi v73, v245, s[44:47], s68 offen offset:0
    buffer_load_short_d16_hi v89, v245, s[44:47], s68 offen offset:64
    buffer_load_short_d16_hi v105, v245, s[44:47], s68 offen offset:128
    s_mov_b32 s68, 23040
    buffer_load_short_d16_hi v74, v245, s[44:47], s68 offen offset:0
    buffer_load_short_d16_hi v90, v245, s[44:47], s68 offen offset:64
    buffer_load_short_d16_hi v106, v245, s[44:47], s68 offen offset:128
    s_mov_b32 s68, 24320
    buffer_load_short_d16_hi v75, v245, s[44:47], s68 offen offset:0
    buffer_load_short_d16_hi v91, v245, s[44:47], s68 offen offset:64
    buffer_load_short_d16_hi v107, v245, s[44:47], s68 offen offset:128
    s_mov_b32 s68, 30720
    buffer_load_short_d16_hi v76, v245, s[44:47], s68 offen offset:0
    buffer_load_short_d16_hi v92, v245, s[44:47], s68 offen offset:64
    buffer_load_short_d16_hi v108, v245, s[44:47], s68 offen offset:128
    s_mov_b32 s68, 32000
    buffer_load_short_d16_hi v77, v245, s[44:47], s68 offen offset:0
    buffer_load_short_d16_hi v93, v245, s[44:47], s68 offen offset:64
    buffer_load_short_d16_hi v109, v245, s[44:47], s68 offen offset:128
    s_mov_b32 s68, 33280
    buffer_load_short_d16_hi v78, v245, s[44:47], s68 offen offset:0
    buffer_load_short_d16_hi v94, v245, s[44:47], s68 offen offset:64
    buffer_load_short_d16_hi v110, v245, s[44:47], s68 offen offset:128
    s_mov_b32 s68, 34560
    buffer_load_short_d16_hi v79, v245, s[44:47], s68 offen offset:0
    buffer_load_short_d16_hi v95, v245, s[44:47], s68 offen offset:64
    buffer_load_short_d16_hi v111, v245, s[44:47], s68 offen offset:128
    buffer_load_dword v13, v244, s[36:39], 0 offen sc1
    s_waitcnt vmcnt(1)
    v_lshlrev_b32 v8, 16, v8
    v_mul_f32 v64, v64, v8
    v_mul_f32 v65, v65, v8
    v_cvt_pk_bf16_f32 v65, v64, v65
    v_lshlrev_b32 v16, 16, v65
    v_and_b32 v17, 0xffff0000, v65
    v_mul_f32 v66, v66, v8
    v_mul_f32 v67, v67, v8
    v_cvt_pk_bf16_f32 v67, v66, v67
    v_lshlrev_b32 v18, 16, v67
    v_and_b32 v19, 0xffff0000, v67
    v_mul_f32 v68, v68, v8
    v_mul_f32 v69, v69, v8
    v_cvt_pk_bf16_f32 v69, v68, v69
    v_lshlrev_b32 v20, 16, v69
    v_and_b32 v21, 0xffff0000, v69
    v_mul_f32 v70, v70, v8
    v_mul_f32 v71, v71, v8
    v_cvt_pk_bf16_f32 v71, v70, v71
    v_lshlrev_b32 v22, 16, v71
    v_and_b32 v23, 0xffff0000, v71
    v_mul_f32 v72, v72, v8
    v_mul_f32 v73, v73, v8
    v_cvt_pk_bf16_f32 v73, v72, v73
    v_lshlrev_b32 v24, 16, v73
    v_and_b32 v25, 0xffff0000, v73
    v_mul_f32 v74, v74, v8
    v_mul_f32 v75, v75, v8
    v_cvt_pk_bf16_f32 v75, v74, v75
    v_lshlrev_b32 v26, 16, v75
    v_and_b32 v27, 0xffff0000, v75
    v_mul_f32 v76, v76, v8
    v_mul_f32 v77, v77, v8
    v_cvt_pk_bf16_f32 v77, v76, v77
    v_lshlrev_b32 v28, 16, v77
    v_and_b32 v29, 0xffff0000, v77
    v_mul_f32 v78, v78, v8
    v_mul_f32 v79, v79, v8
    v_cvt_pk_bf16_f32 v79, v78, v79
    v_lshlrev_b32 v30, 16, v79
    v_and_b32 v31, 0xffff0000, v79
    v_lshlrev_b32 v9, 16, v9
    v_mul_f32 v80, v80, v9
    v_mul_f32 v81, v81, v9
    v_cvt_pk_bf16_f32 v81, v80, v81
    v_lshlrev_b32 v32, 16, v81
    v_and_b32 v33, 0xffff0000, v81
    v_mul_f32 v82, v82, v9
    v_mul_f32 v83, v83, v9
    v_cvt_pk_bf16_f32 v83, v82, v83
    v_lshlrev_b32 v34, 16, v83
    v_and_b32 v35, 0xffff0000, v83
    v_mul_f32 v84, v84, v9
    v_mul_f32 v85, v85, v9
    v_cvt_pk_bf16_f32 v85, v84, v85
    v_lshlrev_b32 v36, 16, v85
    v_and_b32 v37, 0xffff0000, v85
    v_mul_f32 v86, v86, v9
    v_mul_f32 v87, v87, v9
    v_cvt_pk_bf16_f32 v87, v86, v87
    v_lshlrev_b32 v38, 16, v87
    v_and_b32 v39, 0xffff0000, v87
    v_mul_f32 v88, v88, v9
    v_mul_f32 v89, v89, v9
    v_cvt_pk_bf16_f32 v89, v88, v89
    v_lshlrev_b32 v40, 16, v89
    v_and_b32 v41, 0xffff0000, v89
    v_mul_f32 v90, v90, v9
    v_mul_f32 v91, v91, v9
    v_cvt_pk_bf16_f32 v91, v90, v91
    v_lshlrev_b32 v42, 16, v91
    v_and_b32 v43, 0xffff0000, v91
    v_mul_f32 v92, v92, v9
    v_mul_f32 v93, v93, v9
    v_cvt_pk_bf16_f32 v93, v92, v93
    v_lshlrev_b32 v44, 16, v93
    v_and_b32 v45, 0xffff0000, v93
    v_mul_f32 v94, v94, v9
    v_mul_f32 v95, v95, v9
    v_cvt_pk_bf16_f32 v95, v94, v95
    v_lshlrev_b32 v46, 16, v95
    v_and_b32 v47, 0xffff0000, v95
    v_lshlrev_b32 v10, 16, v10
    v_mul_f32 v96, v96, v10
    v_mul_f32 v97, v97, v10
    v_cvt_pk_bf16_f32 v97, v96, v97
    v_lshlrev_b32 v48, 16, v97
    v_and_b32 v49, 0xffff0000, v97
    v_mul_f32 v98, v98, v10
    v_mul_f32 v99, v99, v10
    v_cvt_pk_bf16_f32 v99, v98, v99
    v_lshlrev_b32 v50, 16, v99
    v_and_b32 v51, 0xffff0000, v99
    v_mul_f32 v100, v100, v10
    v_mul_f32 v101, v101, v10
    v_cvt_pk_bf16_f32 v101, v100, v101
    v_lshlrev_b32 v52, 16, v101
    v_and_b32 v53, 0xffff0000, v101
    v_mul_f32 v102, v102, v10
    v_mul_f32 v103, v103, v10
    v_cvt_pk_bf16_f32 v103, v102, v103
    v_lshlrev_b32 v54, 16, v103
    v_and_b32 v55, 0xffff0000, v103
    v_mul_f32 v104, v104, v10
    v_mul_f32 v105, v105, v10
    v_cvt_pk_bf16_f32 v105, v104, v105
    v_lshlrev_b32 v56, 16, v105
    v_and_b32 v57, 0xffff0000, v105
    v_mul_f32 v106, v106, v10
    v_mul_f32 v107, v107, v10
    v_cvt_pk_bf16_f32 v107, v106, v107
    v_lshlrev_b32 v58, 16, v107
    v_and_b32 v59, 0xffff0000, v107
    v_mul_f32 v108, v108, v10
    v_mul_f32 v109, v109, v10
    v_cvt_pk_bf16_f32 v109, v108, v109
    v_lshlrev_b32 v60, 16, v109
    v_and_b32 v61, 0xffff0000, v109
    v_mul_f32 v110, v110, v10
    v_mul_f32 v111, v111, v10
    v_cvt_pk_bf16_f32 v111, v110, v111
    v_lshlrev_b32 v62, 16, v111
    v_and_b32 v63, 0xffff0000, v111
    s_mov_b32 s69, 0
Lpoll_5:
    s_waitcnt vmcnt(0)
    v_cmp_eq_u32 vcc, s60, v13
    s_cmp_eq_u64 vcc, -1
    s_cbranch_scc1 Lpollok_6
    s_sleep 1
    buffer_load_dword v13, v244, s[36:39], 0 offen sc1
    s_add_u32 s69, s69, 1
    s_cmp_lt_u32 s69, 0x40000
    s_cbranch_scc1 Lpoll_5
    s_waitcnt vmcnt(0)
Lpollok_6:
    s_lshl_b32 s70, s83, 13
    s_add_u32 s71, s70, 4096
    buffer_load_dwordx4 v[112:115], v240, s[36:39], s70 offen offset:0 sc1
    buffer_load_dwordx4 v[116:119], v240, s[36:39], s70 offen offset:1024 sc1
    buffer_load_dwordx4 v[120:123], v240, s[36:39], s70 offen offset:2048 sc1
    buffer_load_dwordx4 v[124:127], v240, s[36:39], s70 offen offset:3072 sc1
    buffer_load_dwordx4 v[128:131], v240, s[36:39], s71 offen offset:0 sc1
    buffer_load_dwordx4 v[132:135], v240, s[36:39], s71 offen offset:1024 sc1
    buffer_load_dwordx4 v[136:139], v240, s[36:39], s71 offen offset:2048 sc1
    buffer_load_dwordx4 v[140:143], v240, s[36:39], s71 offen offset:3072 sc1
    s_add_u32 s70, s70, 8192
    s_cmp_eq_u32 s70, 81920
    s_cselect_b32 s70, 0, s70
    s_add_u32 s71, s70, 4096
    buffer_load_dwordx4 v[144:147], v240, s[36:39], s70 offen offset:0 sc1
    buffer_load_dwordx4 v[148:151], v240, s[36:39], s70 offen offset:1024 sc1
    buffer_load_dwordx4 v[152:155], v240, s[36:39], s70 offen offset:2048 sc1
    buffer_load_dwordx4 v[156:159], v240, s[36:39], s70 offen offset:3072 sc1
    buffer_load_dwordx4 v[160:163], v240, s[36:39], s71 offen offset:0 sc1
    buffer_load_dwordx4 v[164:167], v240, s[36:39], s71 offen offset:1024 sc1
    buffer_load_dwordx4 v[168:171], v240, s[36:39], s71 offen offset:2048 sc1
    buffer_load_dwordx4 v[172:175], v240, s[36:39], s71 offen offset:3072 sc1
    s_add_u32 s70, s70, 8192
    s_cmp_eq_u32 s70, 81920
    s_cselect_b32 s70, 0, s70
    s_mov_b32 s74, 0
    s_mov_b32 s73, 16384
    s_barrier
    v_add_u32 v4, s73, v242
    s_add_u32 s73, s73, 24576
    s_cmp_ge_u32 s73, 163840
    s_cselect_b32 s73, 16384, s73
    v_xor_b32 v5, 0, v4
    ds_read_b128 v[176:179], v5 offset:0
    ds_read_b128 v[180:183], v5 offset:4096
    ds_read_b128 v[184:187], v5 offset:8192
    v_xor_b32 v6, 16, v4
    ds_read_b128 v[188:191], v6 offset:0
    ds_read_b128 v[192:195], v6 offset:4096
    ds_read_b128 v[196:199], v6 offset:8192
.p2align 6
LP2B_loop:
    s_cmp_ge_u32 s74, 4
    s_cselect_b32 s70, 1073741824, s70
    s_add_u32 s71, s70, 4096
    v_xor_b32 v5, 32, v4
    s_waitcnt vmcnt(15) lgkmcnt(3)
    v_mfma_f32_32x32x16_bf16 v[16:31], v[112:115], v[176:179], v[16:31]
    ds_read_b128 v[200:203], v5 offset:0
    v_mfma_f32_32x32x16_bf16 v[32:47], v[112:115], v[180:183], v[32:47]
    ds_read_b128 v[204:207], v5 offset:4096
    v_mfma_f32_32x32x16_bf16 v[48:63], v[112:115], v[184:187], v[48:63]
    ds_read_b128 v[208:211], v5 offset:8192
    buffer_load_dwordx4 v[112:115], v240, s[36:39], s70 offen offset:0 sc1
    v_xor_b32 v6, 48, v4
    s_waitcnt vmcnt(15) lgkmcnt(3)
    v_mfma_f32_32x32x16_bf16 v[16:31], v[116:119], v[188:191], v[16:31]
    ds_read_b128 v[212:215], v6 offset:0
    v_mfma_f32_32x32x16_bf16 v[32:47], v[116:119], v[192:195], v[32:47]
    ds_read_b128 v[216:219], v6 offset:4096
    v_mfma_f32_32x32x16_bf16 v[48:63], v[116:119], v[196:199], v[48:63]
    ds_read_b128 v[220:223], v6 offset:8192
    buffer_load_dwordx4 v[116:119], v240, s[36:39], s70 offen offset:1024 sc1
    v_xor_b32 v5, 64, v4
    s_waitcnt vmcnt(15) lgkmcnt(3)
    v_mfma_f32_32x32x16_bf16 v[16:31], v[120:123], v[200:203], v[16:31]
    ds_read_b128 v[176:179], v5 offset:0
    v_mfma_f32_32x32x16_bf16 v[32:47], v[120:123], v[204:207], v[32:47]
    ds_read_b128 v[180:183], v5 offset:4096
    v_mfma_f32_32x32x16_bf16 v[48:63], v[120:123], v[208:211], v[48:63]
    ds_read_b128 v[184:187], v5 offset:8192
    buffer_load_dwordx4 v[120:123], v240, s[36:39], s70 offen offset:2048 sc1
    v_xor_b32 v6, 80, v4
    s_waitcnt vmcnt(15) lgkmcnt(3)
    v_mfma_f32_32x32x16_bf16 v[16:31], v[124:127], v[212:215], v[16:31]
    ds_read_b128 v[188:191], v6 offset:0
    v_mfma_f32_32x32x16_bf16 v[32:47], v[124:127], v[216:219], v[32:47]
    ds_read_b128 v[192:195], v6 offset:4096
    v_mfma_f32_32x32x16_bf16 v[48:63], v[124:127], v[220:223], v[48:63]
    ds_read_b128 v[196:199], v6 offset:8192
    buffer_load_dwordx4 v[124:127], v240, s[36:39], s70 offen offset:3072 sc1
    v_xor_b32 v5, 96, v4
    s_waitcnt vmcnt(15) lgkmcnt(3)
    v_mfma_f32_32x32x16_bf16 v[16:31], v[128:131], v[176:179], v[16:31]
    ds_read_b128 v[200:203], v5 offset:0
    v_mfma_f32_32x32x16_bf16 v[32:47], v[128:131], v[180:183], v[32:47]
    ds_read_b128 v[204:207], v5 offset:4096
    v_mfma_f32_32x32x16_bf16 v[48:63], v[128:131], v[184:187], v[48:63]
    ds_read_b128 v[208:211], v5 offset:8192
    buffer_load_dwordx4 v[128:131], v240, s[36:39], s71 offen offset:0 sc1
    v_xor_b32 v6, 112, v4
    s_waitcnt vmcnt(15) lgkmcnt(3)
    v_mfma_f32_32x32x16_bf16 v[16:31], v[132:135], v[188:191], v[16:31]
    ds_read_b128 v[212:215], v6 offset:0
    v_mfma_f32_32x32x16_bf16 v[32:47], v[132:135], v[192:195], v[32:47]
    ds_read_b128 v[216:219], v6 offset:4096
    v_mfma_f32_32x32x16_bf16 v[48:63], v[132:135], v[196:199], v[48:63]
    ds_read_b128 v[220:223], v6 offset:8192
    buffer_load_dwordx4 v[132:135], v240, s[36:39], s71 offen offset:1024 sc1
    v_add_u32 v4, s73, v242
    s_add_u32 s73, s73, 24576
    s_cmp_ge_u32 s73, 163840
    s_cselect_b32 s73, 16384, s73
    v_xor_b32 v5, 0, v4
    s_waitcnt vmcnt(15) lgkmcnt(3)
    v_mfma_f32_32x32x16_bf16 v[16:31], v[136:139], v[200:203], v[16:31]
    ds_read_b128 v[176:179], v5 offset:0
    v_mfma_f32_32x32x16_bf16 v[32:47], v[136:139], v[204:207], v[32:47]
    ds_read_b128 v[180:183], v5 offset:4096
    v_mfma_f32_32x32x16_bf16 v[48:63], v[136:139], v[208:211], v[48:63]
    ds_read_b128 v[184:187], v5 offset:8192
    buffer_load_dwordx4 v[136:139], v240, s[36:39], s71 offen offset:2048 sc1
    v_xor_b32 v6, 16, v4
    s_waitcnt vmcnt(15) lgkmcnt(3)
    v_mfma_f32_32x32x16_bf16 v[16:31], v[140:143], v[212:215], v[16:31]
    ds_read_b128 v[188:191], v6 offset:0
    v_mfma_f32_32x32x16_bf16 v[32:47], v[140:143], v[216:219], v[32:47]
    ds_read_b128 v[192:195], v6 offset:4096
    v_mfma_f32_32x32x16_bf16 v[48:63], v[140:143], v[220:223], v[48:63]
    ds_read_b128 v[196:199], v6 offset:8192
    buffer_load_dwordx4 v[140:143], v240, s[36:39], s71 offen offset:3072 sc1
    s_add_u32 s70, s70, 8192
    s_cmp_eq_u32 s70, 81920
    s_cselect_b32 s70, 0, s70
    s_add_u32 s71, s70, 4096
    v_xor_b32 v5, 32, v4
    s_waitcnt vmcnt(15) lgkmcnt(3)
    v_mfma_f32_32x32x16_bf16 v[16:31], v[144:147], v[176:179], v[16:31]
    ds_read_b128 v[200:203], v5 offset:0
    v_mfma_f32_32x32x16_bf16 v[32:47], v[144:147], v[180:183], v[32:47]
    ds_read_b128 v[204:207], v5 offset:4096
    v_mfma_f32_32x32x16_bf16 v[48:63], v[144:147], v[184:187], v[48:63]
    ds_read_b128 v[208:211], v5 offset:8192
    buffer_load_dwordx4 v[144:147], v240, s[36:39], s70 offen offset:0 sc1
    v_xor_b32 v6, 48, v4
    s_waitcnt vmcnt(15) lgkmcnt(3)
    v_mfma_f32_32x32x16_bf16 v[16:31], v[148:151], v[188:191], v[16:31]
    ds_read_b128 v[212:215], v6 offset:0
    v_mfma_f32_32x32x16_bf16 v[32:47], v[148:151], v[192:195], v[32:47]
    ds_read_b128 v[216:219], v6 offset:4096
    v_mfma_f32_32x32x16_bf16 v[48:63], v[148:151], v[196:199], v[48:63]
    ds_read_b128 v[220:223], v6 offset:8192
    buffer_load_dwordx4 v[148:151], v240, s[36:39], s70 offen offset:1024 sc1
    v_xor_b32 v5, 64, v4
    s_waitcnt vmcnt(15) lgkmcnt(3)
    v_mfma_f32_32x32x16_bf16 v[16:31], v[152:155], v[200:203], v[16:31]
    ds_read_b128 v[176:179], v5 offset:0
    v_mfma_f32_32x32x16_bf16 v[32:47], v[152:155], v[204:207], v[32:47]
    ds_read_b128 v[180:183], v5 offset:4096
    v_mfma_f32_32x32x16_bf16 v[48:63], v[152:155], v[208:211], v[48:63]
    ds_read_b128 v[184:187], v5 offset:8192
    buffer_load_dwordx4 v[152:155], v240, s[36:39], s70 offen offset:2048 sc1
    v_xor_b32 v6, 80, v4
    s_waitcnt vmcnt(15) lgkmcnt(3)
    v_mfma_f32_32x32x16_bf16 v[16:31], v[156:159], v[212:215], v[16:31]
    ds_read_b128 v[188:191], v6 offset:0
    v_mfma_f32_32x32x16_bf16 v[32:47], v[156:159], v[216:219], v[32:47]
    ds_read_b128 v[192:195], v6 offset:4096
    v_mfma_f32_32x32x16_bf16 v[48:63], v[156:159], v[220:223], v[48:63]
    ds_read_b128 v[196:199], v6 offset:8192
    buffer_load_dwordx4 v[156:159], v240, s[36:39], s70 offen offset:3072 sc1
    v_xor_b32 v5, 96, v4
    s_waitcnt vmcnt(15) lgkmcnt(3)
    v_mfma_f32_32x32x16_bf16 v[16:31], v[160:163], v[176:179], v[16:31]
    ds_read_b128 v[200:203], v5 offset:0
    v_mfma_f32_32x32x16_bf16 v[32:47], v[160:163], v[180:183], v[32:47]
    ds_read_b128 v[204:207], v5 offset:4096
    v_mfma_f32_32x32x16_bf16 v[48:63], v[160:163], v[184:187], v[48:63]
    ds_read_b128 v[208:211], v5 offset:8192
    buffer_load_dwordx4 v[160:163], v240, s[36:39], s71 offen offset:0 sc1
    v_xor_b32 v6, 112, v4
    s_waitcnt vmcnt(15) lgkmcnt(3)
    v_mfma_f32_32x32x16_bf16 v[16:31], v[164:167], v[188:191], v[16:31]
    ds_read_b128 v[212:215], v6 offset:0
    v_mfma_f32_32x32x16_bf16 v[32:47], v[164:167], v[192:195], v[32:47]
    ds_read_b128 v[216:219], v6 offset:4096
    v_mfma_f32_32x32x16_bf16 v[48:63], v[164:167], v[196:199], v[48:63]
    ds_read_b128 v[220:223], v6 offset:8192
    buffer_load_dwordx4 v[164:167], v240, s[36:39], s71 offen offset:1024 sc1
    s_cmp_ge_u32 s74, 4
    s_cbranch_scc1 LP2B_nb
    s_waitcnt lgkmcnt(0)
    s_barrier
LP2B_nb:
    v_add_u32 v4, s73, v242
    s_add_u32 s73, s73, 24576
    s_cmp_ge_u32 s73, 163840
    s_cselect_b32 s73, 16384, s73
    v_xor_b32 v5, 0, v4
    s_waitcnt vmcnt(15) lgkmcnt(3)
    v_mfma_f32_32x32x16_bf16 v[16:31], v[168:171], v[200:203], v[16:31]
    ds_read_b128 v[176:179], v5 offset:0
    v_mfma_f32_32x32x16_bf16 v[32:47], v[168:171], v[204:207], v[32:47]
    ds_read_b128 v[180:183], v5 offset:4096
    v_mfma_f32_32x32x16_bf16 v[48:63], v[168:171], v[208:211], v[48:63]
    ds_read_b128 v[184:187], v5 offset:8192
    buffer_load_dwordx4 v[168:171], v240, s[36:39], s71 offen offset:2048 sc1
    v_xor_b32 v6, 16, v4
    s_waitcnt vmcnt(15) lgkmcnt(3)
    v_mfma_f32_32x32x16_bf16 v[16:31], v[172:175], v[212:215], v[16:31]
    ds_read_b128 v[188:191], v6 offset:0
    v_mfma_f32_32x32x16_bf16 v[32:47], v[172:175], v[216:219], v[32:47]
    ds_read_b128 v[192:195], v6 offset:4096
    v_mfma_f32_32x32x16_bf16 v[48:63], v[172:175], v[220:223], v[48:63]
    ds_read_b128 v[196:199], v6 offset:8192
    buffer_load_dwordx4 v[172:175], v240, s[36:39], s71 offen offset:3072 sc1
    s_add_u32 s70, s70, 8192
    s_cmp_eq_u32 s70, 81920
    s_cselect_b32 s70, 0, s70
    s_add_u32 s74, s74, 1
    s_cmp_lt_u32 s74, 5
    s_cbranch_scc1 LP2B_loop
    s_mov_b32 s66, 0
    buffer_store_dword v16, v241, s[40:43], s66 offen offset:0 nt
    buffer_store_dword v32, v241, s[40:43], s66 offen offset:128 nt
    s_nop 0
    buffer_store_dword v48, v243, s[40:43], s66 offen offset:256 nt
    s_mov_b32 s66, 5120
    buffer_store_dword v17, v241, s[40:43], s66 offen offset:0 nt
    buffer_store_dword v33, v241, s[40:43], s66 offen offset:128 nt
    buffer_store_dword v49, v243, s[40:43], s66 offen offset:256 nt
    s_mov_b32 s66, 10240
    buffer_store_dword v18, v241, s[40:43], s66 offen offset:0 nt
    buffer_store_dword v34, v241, s[40:43], s66 offen offset:128 nt
    buffer_store_dword v50, v243, s[40:43], s66 offen offset:256 nt
    s_mov_b32 s66, 15360
    buffer_store_dword v19, v241, s[40:43], s66 offen offset:0 nt
    buffer_store_dword v35, v241, s[40:43], s66 offen offset:128 nt
    buffer_store_dword v51, v243, s[40:43], s66 offen offset:256 nt
    s_mov_b32 s66, 40960
    buffer_store_dword v20, v241, s[40:43], s66 offen offset:0 nt
    buffer_store_dword v36, v241, s[40:43], s66 offen offset:128 nt
    buffer_store_dword v52, v243, s[40:43], s66 offen offset:256 nt
    s_mov_b32 s66, 46080
    buffer_store_dword v21, v241, s[40:43], s66 offen offset:0 nt
    buffer_store_dword v37, v241, s[40:43], s66 offen offset:128 nt
    buffer_store_dword v53, v243, s[40:43], s66 offen offset:256 nt
    s_mov_b32 s66, 51200
    buffer_store_dword v22, v241, s[40:43], s66 offen offset:0 nt
    buffer_store_dword v38, v241, s[40:43], s66 offen offset:128 nt
    buffer_store_dword v54, v243, s[40:43], s66 offen offset:256 nt
    s_mov_b32 s66, 56320
    buffer_store_dword v23, v241, s[40:43], s66 offen offset:0 nt
    buffer_store_dword v39, v241, s[40:43], s66 offen offset:128 nt
    buffer_store_dword v55, v243, s[40:43], s66 offen offset:256 nt
    s_mov_b32 s66, 81920
    buffer_store_dword v24, v241, s[40:43], s66 offen offset:0 nt
    buffer_store_dword v40, v241, s[40:43], s66 offen offset:128 nt
    buffer_store_dword v56, v243, s[40:43], s66 offen offset:256 nt
    s_mov_b32 s66, 87040
    buffer_store_dword v25, v241, s[40:43], s66 offen offset:0 nt
    buffer_store_dword v41, v241, s[40:43], s66 offen offset:128 nt
    buffer_store_dword v57, v243, s[40:43], s66 offen offset:256 nt
    s_mov_b32 s66, 92160
    buffer_store_dword v26, v241, s[40:43], s66 offen offset:0 nt
    buffer_store_dword v42, v241, s[40:43], s66 offen offset:128 nt
    buffer_store_dword v58, v243, s[40:43], s66 offen offset:256 nt
    s_mov_b32 s66, 97280
    buffer_store_dword v27, v241, s[40:43], s66 offen offset:0 nt
    buffer_store_dword v43, v241, s[40:43], s66 offen offset:128 nt
    buffer_store_dword v59, v243, s[40:43], s66 offen offset:256 nt
    s_mov_b32 s66, 122880
    buffer_store_dword v28, v241, s[40:43], s66 offen offset:0 nt
    buffer_store_dword v44, v241, s[40:43], s66 offen offset:128 nt
    buffer_store_dword v60, v243, s[40:43], s66 offen offset:256 nt
    s_mov_b32 s66, 128000
    buffer_store_dword v29, v241, s[40:43], s66 offen offset:0 nt
    buffer_store_dword v45, v241, s[40:43], s66 offen offset:128 nt
    buffer_store_dword v61, v243, s[40:43], s66 offen offset:256 nt
    s_mov_b32 s66, 133120
    buffer_store_dword v30, v241, s[40:43], s66 offen offset:0 nt
    buffer_store_dword v46, v241, s[40:43], s66 offen offset:128 nt
    buffer_store_dword v62, v243, s[40:43], s66 offen offset:256 nt
    s_mov_b32 s66, 138240
    buffer_store_dword v31, v241, s[40:43], s66 offen offset:0 nt
    buffer_store_dword v47, v241, s[40:43], s66 offen offset:128 nt
    buffer_store_dword v63, v243, s[40:43], s66 offen offset:256 nt
    s_xor_b32 s62, s2, 143
    s_or_b32 s62, s62, s58
    s_cmp_lg_u32 s62, 0
    s_cselect_b32 s63, 1073741824, 128
    s_mul_i32 s60, s60, 0xe8b2f51
    v_mov_b32 v2, 0
    v_mov_b32 v3, s60
    s_mov_b64 exec, 1
    buffer_store_dword v3, v2, s[36:39], s63 offen sc1
    s_mov_b64 exec, -1
    s_endpgm
LB_idle:
    s_endpgm
L_end:
    s_endpgm
.section .rodata,"a"
.p2align 6
.amdhsa_kernel concat_heads__linear_kernel_hedgehog__ssm_conv_s5__prompt_kernel
  .amdhsa_next_free_vgpr 256
  .amdhsa_next_free_sgpr 102
  .amdhsa_accum_offset 256
  .amdhsa_group_segment_fixed_size 0
  .amdhsa_kernarg_size 128
  .amdhsa_user_sgpr_count 2
  .amdhsa_user_sgpr_kernarg_segment_ptr 1
  .amdhsa_system_sgpr_workgroup_id_x 1
.end_amdhsa_kernel
```
